```python
import torch

def _softmax(x, axis=-1):
    return torch.softmax(x, dim=axis)
def _gelu(x):
    return torch.nn.functional.gelu(x, approximate="tanh")
def _silu(x):
    return torch.nn.functional.silu(x)
def _sigmoid(x):
    return torch.sigmoid(x)
def _layernorm(x, axis=-1, eps=1e-5):
    m = x.mean(dim=axis, keepdim=True)
    v = x.var(dim=axis, keepdim=True, unbiased=False)
    return (x - m) / torch.sqrt(v + eps)
def _scatter_add(tgt, idx, src, axis=0):
    return tgt.clone().index_add_(axis, idx, src)
def _segment_sum(src, seg, n):
    out = torch.zeros((n,) + src.shape[1:], dtype=src.dtype)
    return out.index_add_(0, seg, src)
def _pad(x, pw):
    flat = tuple(v for pair in reversed(pw) for v in pair)
    return torch.nn.functional.pad(x, flat)

kernel_name = 'sequential_preLN__sliding_block_cached__glu_gated_bilinear__decode'

def setup_inputs():

    _w = (lambda a: (lambda t: t.to(torch.bfloat16) if t.is_floating_point() else t)(torch.as_tensor(a)))
    def _A_setup():
        B, Sq, D = 2, 1, 448
        Hq, Hkv, Sk, Dh = 16, 8, 32768, 256
        assert Hq % Hkv == 0, (Hq, Hkv)
        return {
            "x": _w((lambda *s: torch.randn(*s, dtype=torch.bfloat16) * 0.05)(B, Sq, D)),
            "k_cache": _w((lambda *s: torch.randn(*s, dtype=torch.bfloat16) * 1.6)(B, Hkv, Sk, Dh)),
            "v_cache": _w((lambda *s: torch.randn(*s, dtype=torch.bfloat16) * 0.8)(B, Hkv, Sk, Dh)),
            "wq": _w((lambda *s: torch.randn(*s, dtype=torch.bfloat16) * 1.6)(D, Hq * Dh) * (D ** -0.5)),
            "wo": _w((lambda *s: torch.randn(*s, dtype=torch.bfloat16) * 0.8)(Hq * Dh, D) * ((Hq * Dh) ** -0.5)),
        }
    _A_in = _A_setup()

    def _B_setup():
        B, S, D, F = 2, 1, 448, 1792
        return {
            "x": _w((lambda *s: torch.randn(*s, dtype=torch.bfloat16) * 0.05)(B, S, D)),
            "w_gate": _w((lambda *s: torch.randn(*s, dtype=torch.bfloat16) * 0.4)(D, F) * (D ** -0.5)),
            "w_up": _w((lambda *s: torch.randn(*s, dtype=torch.bfloat16) * 0.4)(D, F) * (D ** -0.5)),
            "w_down": _w((lambda *s: torch.randn(*s, dtype=torch.bfloat16) * 0.4)(F, D) * (F ** -0.5)),
        }
    _B_in = _B_setup()

    return {
        "A_x": _A_in["x"],
        "A_k_cache": _A_in["k_cache"],
        "A_v_cache": _A_in["v_cache"],
        "A_wq": _A_in["wq"],
        "A_wo": _A_in["wo"],
        "B_x": _B_in["x"],
        "B_w_gate": _B_in["w_gate"],
        "B_w_up": _B_in["w_up"],
        "B_w_down": _B_in["w_down"],
    }

def reference(A_x, A_k_cache, A_v_cache, A_wq, A_wo, B_x, B_w_gate, B_w_up, B_w_down):
    def _A_ref(x, k_cache, v_cache, wq, wo):
        B, Sq, D = x.shape
        Hq, Dh = 16, 256
        Hkv, Sk = k_cache.shape[1], k_cache.shape[2]
        W = min(4096, max(256, Sk // 4))
        rep = Hq // Hkv
        q = (lambda x, *d: x.permute(*d))((x @ wq).reshape(B, Sq, Hq, Dh), 0, 2, 1, 3)
        k = (lambda x, n, axis: torch.repeat_interleave(x, n, dim=axis))(k_cache[:, :, Sk - W:, :], rep, axis=1)
        v = (lambda x, n, axis: torch.repeat_interleave(x, n, dim=axis))(v_cache[:, :, Sk - W:, :], rep, axis=1)
        scores = torch.einsum("bhqd,bhkd->bhqk", q, k) * (Dh ** -0.5)
        p = _softmax(scores, axis=-1)
        o = torch.einsum("bhqk,bhkd->bhqd", p, v)
        return (lambda x, *d: x.permute(*d))(o, 0, 2, 1, 3).reshape(B, Sq, Hq * Dh) @ wo

    def _B_ref(x, w_gate, w_up, w_down):
        g = torch.einsum("bsd,df->bsf", x, w_gate)
        u = torch.einsum("bsd,df->bsf", x, w_up)
        h = g * u
        return torch.einsum("bsf,fd->bsd", h, w_down)

    x = A_x
    h = x + _A_ref(_layernorm(x, axis=-1), A_k_cache, A_v_cache, A_wq, A_wo)
    h2 = h + _B_ref(_layernorm(h, axis=-1), B_w_gate, B_w_up, B_w_down)
    return h2
```

```asm
; @launch grid=(256,1,1) block=(512,1,1) lds=157696
.amdgcn_target "amdgcn-amd-amdhsa--gfx950"
.text
.globl sequential_preLN__sliding_block_cached__glu_gated_bilinear__decode_kernel
.p2align 12
.p2align 8
.type sequential_preLN__sliding_block_cached__glu_gated_bilinear__decode_kernel,@function
sequential_preLN__sliding_block_cached__glu_gated_bilinear__decode_kernel:
    s_cmp_ge_u32 s2, 256
    s_cbranch_scc1 L_end0
    s_load_dwordx16 s[16:31], s[0:1], 0
    s_load_dwordx8 s[32:39], s[0:1], 64
    v_lshrrev_b32 v1, 6, v0
    v_and_b32 v0, 63, v0
    v_readfirstlane_b32 s3, v1
    v_and_b32 v2, 31, v0
    v_mov_b32 v7, 0x26700
    v_lshl_add_u32 v3, v2, 2, v7
    v_mov_b32 v4, 0
    ds_write_b32 v3, v4
    s_and_b32 s4, s2, 7
    s_lshr_b32 s5, s2, 3
    s_lshr_b32 s6, s5, 4
    s_and_b32 s7, s5, 15
    s_lshl_b32 s8, s4, 5
    s_add_u32 s8, s8, s5
    s_and_b32 s9, s3, 3
    s_add_u32 s81, s5, 14
    s_and_b32 s81, s81, 31
    v_lshl_add_u32 v6, s9, 2, v7
    v_mov_b32 v5, 1
    s_cmp_ge_u32 s3, 4
    s_cbranch_scc1 L_helper
    v_lshrrev_b32 v1, 3, v0
    v_and_b32 v4, 7, v0
    v_lshlrev_b32 v4, 4, v4
    v_lshl_add_u32 v16, v1, 13, v4
    s_lshr_b32 s10, s81, 3
    s_lshl2_add_u32 s10, s9, s10
    s_lshl_b32 s10, s10, 18
    s_and_b32 s11, s81, 7
    s_lshl3_add_u32 s11, s4, s11
    s_lshl_b32 s11, s11, 7
    s_add_u32 s13, s10, s11
    s_lshl_b32 s11, s9, 12
    s_add_u32 m0, s11, 0x20000
    s_mov_b32 s58, 0x380000
    s_mov_b32 s59, 0x20000
    s_mov_b32 s42, 0x10000000
    s_mov_b32 s43, 0x20000
    v_lshrrev_b32 v1, 5, v0
    v_xor_b32 v2, v2, v1
    v_lshlrev_b32 v2, 4, v2
    v_lshl_add_u32 v8, v1, 9, v2
    v_add_u32 v9, 7168, v8
    v_xor_b32 v9, 32, v9
    s_lshl3_add_u32 s10, s6, s4
    s_lshl_b32 s10, s10, 24
    s_add_u32 s80, s10, 0xE00000
    s_bfe_u32 s10, s9, 0x10000
    s_lshl_b32 s10, s10, 12
    s_add_u32 s80, s80, s10
    s_bfe_u32 s10, s9, 0x10001
    s_lshl_b32 s10, s10, 18
    s_add_u32 s80, s80, s10
    s_bfe_u32 s10, s7, 0x20000
    s_lshl_b32 s10, s10, 10
    s_add_u32 s80, s80, s10
    s_bfe_u32 s10, s7, 0x10002
    s_lshl_b32 s10, s10, 14
    s_add_u32 s80, s80, s10
    s_bfe_u32 s10, s7, 0x10003
    s_lshl_b32 s10, s10, 16
    s_add_u32 s80, s80, s10
    s_lshl_b32 s12, s9, 15
    s_waitcnt lgkmcnt(0)
    s_mov_b64 s[56:57], s[22:23]
    s_mov_b64 s[40:41], s[18:19]
    buffer_load_dwordx4 v16, s[56:59], s13 offen nt lds
    s_add_u32 m0, s11, 0x20400
    s_add_u32 s13, s13, 65536
    buffer_load_dwordx4 v16, s[56:59], s13 offen nt lds
    s_add_u32 m0, s11, 0x20800
    s_add_u32 s13, s13, 65536
    buffer_load_dwordx4 v16, s[56:59], s13 offen nt lds
    s_add_u32 m0, s11, 0x20c00
    s_add_u32 s13, s13, 65536
    buffer_load_dwordx4 v16, s[56:59], s13 offen nt lds
    s_add_u32 m0, s12, 0
    s_add_u32 s10, s80, 0x0
    buffer_load_dwordx4 v8, s[40:43], s10 offen offset:0 nt lds
    buffer_load_dwordx4 v9, s[40:43], s10 offen offset:1024 nt lds
    v_xor_b32 v10, 64, v8
    v_xor_b32 v11, 64, v9
    v_xor_b32 v12, 128, v8
    v_xor_b32 v13, 128, v9
    v_xor_b32 v14, 192, v8
    v_xor_b32 v15, 192, v9
    s_add_u32 m0, s12, 2048
    s_add_u32 s10, s80, 0x8000
    buffer_load_dwordx4 v10, s[40:43], s10 offen offset:0 nt lds
    buffer_load_dwordx4 v11, s[40:43], s10 offen offset:1024 nt lds
    s_barrier
    s_waitcnt vmcnt(5)
    s_add_u32 m0, s12, 4096
    s_add_u32 s10, s80, 0x20000
    buffer_load_dwordx4 v12, s[40:43], s10 offen offset:0 nt lds
    s_waitcnt vmcnt(5)
    ds_write_b32 v6, v5 offset:16
    buffer_load_dwordx4 v13, s[40:43], s10 offen offset:1024 nt lds
    s_waitcnt vmcnt(5)
    s_add_u32 m0, s12, 6144
    s_add_u32 s10, s80, 0x28000
    buffer_load_dwordx4 v14, s[40:43], s10 offen offset:0 nt lds
    s_waitcnt vmcnt(5)
    buffer_load_dwordx4 v15, s[40:43], s10 offen offset:1024 nt lds
    s_waitcnt vmcnt(5)
    s_add_u32 m0, s12, 8192
    s_add_u32 s10, s80, 0x80000
    buffer_load_dwordx4 v8, s[40:43], s10 offen offset:0 nt lds
    s_waitcnt vmcnt(5)
    buffer_load_dwordx4 v9, s[40:43], s10 offen offset:1024 nt lds
    s_waitcnt vmcnt(5)
    s_add_u32 m0, s12, 10240
    s_add_u32 s10, s80, 0x88000
    buffer_load_dwordx4 v10, s[40:43], s10 offen offset:0 nt lds
    s_waitcnt vmcnt(5)
    buffer_load_dwordx4 v11, s[40:43], s10 offen offset:1024 nt lds
    s_waitcnt vmcnt(5)
    s_add_u32 m0, s12, 12288
    s_add_u32 s10, s80, 0xa0000
    buffer_load_dwordx4 v12, s[40:43], s10 offen offset:0 nt lds
    s_waitcnt vmcnt(5)
    buffer_load_dwordx4 v13, s[40:43], s10 offen offset:1024 nt lds
    s_waitcnt vmcnt(5)
    s_add_u32 m0, s12, 14336
    s_add_u32 s10, s80, 0xa8000
    buffer_load_dwordx4 v14, s[40:43], s10 offen offset:0 nt lds
    s_waitcnt vmcnt(5)
    buffer_load_dwordx4 v15, s[40:43], s10 offen offset:1024 nt lds
    s_waitcnt vmcnt(5)
    s_add_u32 m0, s12, 16384
    s_add_u32 s10, s80, 0x100000
    buffer_load_dwordx4 v8, s[40:43], s10 offen offset:0 nt lds
    s_waitcnt vmcnt(5)
    buffer_load_dwordx4 v9, s[40:43], s10 offen offset:1024 nt lds
    s_waitcnt vmcnt(5)
    s_add_u32 m0, s12, 18432
    s_add_u32 s10, s80, 0x108000
    buffer_load_dwordx4 v10, s[40:43], s10 offen offset:0 nt lds
    s_waitcnt vmcnt(5)
    buffer_load_dwordx4 v11, s[40:43], s10 offen offset:1024 nt lds
    s_waitcnt vmcnt(5)
    s_add_u32 m0, s12, 20480
    s_add_u32 s10, s80, 0x120000
    buffer_load_dwordx4 v12, s[40:43], s10 offen offset:0 nt lds
    s_waitcnt vmcnt(5)
    s_mov_b32 s44, s20
    s_mov_b32 s45, s21
    s_mov_b32 s46, 0x10000000
    s_mov_b32 s47, 0x20000
    s_mov_b32 s48, s38
    s_mov_b32 s49, s39
    s_mov_b32 s50, 0x200000
    s_mov_b32 s51, 0x20000
    v_bfe_u32 v1, v0, 4, 1
    v_and_b32 v2, 15, v0
    v_lshlrev_b32 v2, 4, v2
    v_lshl_add_u32 v16, v1, 9, v2
    v_lshrrev_b32 v1, 5, v0
    v_lshl_add_u32 v16, v1, 13, v16
    buffer_load_dwordx4 v13, s[40:43], s10 offen offset:1024 nt lds
    s_waitcnt vmcnt(5)
    s_add_u32 m0, s12, 22528
    s_add_u32 s10, s80, 0x128000
    buffer_load_dwordx4 v14, s[40:43], s10 offen offset:0 nt lds
    s_waitcnt vmcnt(5)
    buffer_load_dwordx4 v15, s[40:43], s10 offen offset:1024 nt lds
    s_waitcnt vmcnt(5)
    v_mov_b32 v17, 2
    ds_write_b32 v6, v17 offset:16
    s_add_u32 m0, s12, 24576
    s_add_u32 s10, s80, 0x180000
    buffer_load_dwordx4 v8, s[40:43], s10 offen offset:0 nt lds
    s_waitcnt vmcnt(5)
    buffer_load_dwordx4 v9, s[40:43], s10 offen offset:1024 nt lds
    s_waitcnt vmcnt(5)
    s_add_u32 m0, s12, 26624
    s_add_u32 s10, s80, 0x188000
    buffer_load_dwordx4 v10, s[40:43], s10 offen offset:0 nt lds
    s_waitcnt vmcnt(5)
    buffer_load_dwordx4 v11, s[40:43], s10 offen offset:1024 nt lds
    s_waitcnt vmcnt(5)
    s_add_u32 m0, s12, 28672
    s_add_u32 s10, s80, 0x1a0000
    buffer_load_dwordx4 v12, s[40:43], s10 offen offset:0 nt lds
    s_waitcnt vmcnt(5)
    buffer_load_dwordx4 v13, s[40:43], s10 offen offset:1024 nt lds
    s_waitcnt vmcnt(5)
    s_add_u32 m0, s12, 30720
    s_add_u32 s10, s80, 0x1a8000
    buffer_load_dwordx4 v14, s[40:43], s10 offen offset:0 nt lds
    s_waitcnt vmcnt(5)
    buffer_load_dwordx4 v15, s[40:43], s10 offen offset:1024 nt lds
    s_waitcnt vmcnt(5)
    s_add_u32 s10, s80, 0x0
    buffer_load_dwordx4 v[64:67], v16, s[44:47], s10 offen offset:0 nt
    s_waitcnt vmcnt(5)
    buffer_load_dwordx4 v[68:71], v16, s[44:47], s10 offen offset:256 nt
    s_waitcnt vmcnt(5)
    s_add_u32 s10, s80, 0x8000
    buffer_load_dwordx4 v[72:75], v16, s[44:47], s10 offen offset:0 nt
    s_waitcnt vmcnt(5)
    buffer_load_dwordx4 v[76:79], v16, s[44:47], s10 offen offset:256 nt
    s_waitcnt vmcnt(5)
    s_add_u32 s10, s80, 0x20000
    buffer_load_dwordx4 v[80:83], v16, s[44:47], s10 offen offset:0 nt
    s_waitcnt vmcnt(5)
    v_mov_b32 v9, 13
    ds_write_b32 v6, v9 offset:16
    buffer_load_dwordx4 v[84:87], v16, s[44:47], s10 offen offset:256 nt
    s_waitcnt vmcnt(6)
    s_add_u32 s10, s80, 0x28000
    buffer_load_dwordx4 v[88:91], v16, s[44:47], s10 offen offset:0 nt
    s_waitcnt vmcnt(6)
    v_and_b32 v1, 1, v0
    v_lshlrev_b32 v1, 4, v1
    v_mov_b32 v2, 0xffff
    v_lshlrev_b32 v2, v1, v2
    v_bfe_u32 v1, v0, 1, 2
    v_cmp_eq_u32 vcc, 0, v1
    s_nop 1
    v_cndmask_b32 v20, 0, v2, vcc
    v_cmp_eq_u32 vcc, 1, v1
    s_nop 1
    v_cndmask_b32 v21, 0, v2, vcc
    v_cmp_eq_u32 vcc, 2, v1
    s_nop 1
    v_cndmask_b32 v22, 0, v2, vcc
    v_cmp_eq_u32 vcc, 3, v1
    s_nop 1
    v_cndmask_b32 v23, 0, v2, vcc
    v_bfe_u32 v1, v0, 3, 1
    v_lshlrev_b32 v1, 8, v1
    v_lshrrev_b32 v2, 4, v0
    v_lshl_add_u32 v1, v2, 6, v1
    s_lshl_b32 s11, s9, 9
    s_add_u32 s11, s11, 0x25f00
    v_add_u32 v17, s11, v1
    s_lshl_b32 s11, s9, 11
    s_add_u32 s11, s11, 0x20000
    v_lshlrev_b32 v1, 4, v0
    v_add_u32 v18, s11, v1
    buffer_load_dwordx4 v[92:95], v16, s[44:47], s10 offen offset:256 nt
    s_waitcnt vmcnt(6)
    s_add_u32 s10, s80, 0x80000
    buffer_load_dwordx4 v[96:99], v16, s[44:47], s10 offen offset:0 nt
    s_waitcnt vmcnt(6)
    v_and_b32 v1, 47, v0
    v_lshlrev_b32 v1, 4, v1
    v_bfe_u32 v2, v0, 4, 1
    v_lshl_add_u32 v1, v2, 10, v1
    v_add_u32 v19, 0x20000, v1
    v_lshrrev_b32 v1, 5, v0
    v_lshl_add_u32 v4, v1, 4, v7
    v_lshl_add_u32 v8, s9, 2, v4
    v_lshlrev_b32 v3, 8, v0
    s_lshr_b32 s13, s8, 4
    s_lshl_b32 s13, s13, 14
    s_lshl4_add_u32 s13, s7, s13
    s_add_u32 s13, s13, 0x40000
    buffer_load_dwordx4 v[100:103], v16, s[44:47], s10 offen offset:256 nt
    s_waitcnt vmcnt(6)
    s_add_u32 s10, s80, 0x88000
    buffer_load_dwordx4 v[104:107], v16, s[44:47], s10 offen offset:0 nt
    s_waitcnt vmcnt(6)
    buffer_load_dwordx4 v[108:111], v16, s[44:47], s10 offen offset:256 nt
    s_waitcnt vmcnt(6)
    s_add_u32 s10, s80, 0xa0000
    buffer_load_dwordx4 v[112:115], v16, s[44:47], s10 offen offset:0 nt
    s_waitcnt vmcnt(6)
    buffer_load_dwordx4 v[116:119], v16, s[44:47], s10 offen offset:256 nt
    s_waitcnt vmcnt(6)
    s_add_u32 s10, s80, 0xa8000
    buffer_load_dwordx4 v[120:123], v16, s[44:47], s10 offen offset:0 nt
    s_waitcnt vmcnt(6)
    buffer_load_dwordx4 v[124:127], v16, s[44:47], s10 offen offset:256 nt
    s_waitcnt vmcnt(6)
    s_add_u32 s10, s80, 0x100000
    buffer_load_dwordx4 v[128:131], v16, s[44:47], s10 offen offset:0 nt
    s_waitcnt vmcnt(6)
    buffer_load_dwordx4 v[132:135], v16, s[44:47], s10 offen offset:256 nt
    s_waitcnt vmcnt(6)
    s_add_u32 s10, s80, 0x108000
    buffer_load_dwordx4 v[136:139], v16, s[44:47], s10 offen offset:0 nt
    s_waitcnt vmcnt(6)
    buffer_load_dwordx4 v[140:143], v16, s[44:47], s10 offen offset:256 nt
    s_waitcnt vmcnt(6)
    s_add_u32 s10, s80, 0x120000
    buffer_load_dwordx4 v[144:147], v16, s[44:47], s10 offen offset:0 nt
    s_waitcnt vmcnt(6)
    buffer_load_dwordx4 v[148:151], v16, s[44:47], s10 offen offset:256 nt
    s_waitcnt vmcnt(6)
    s_add_u32 s10, s80, 0x128000
    buffer_load_dwordx4 v[152:155], v16, s[44:47], s10 offen offset:0 nt
    s_waitcnt vmcnt(6)
    buffer_load_dwordx4 v[156:159], v16, s[44:47], s10 offen offset:256 nt
    s_waitcnt vmcnt(6)
    s_add_u32 s10, s80, 0x180000
    buffer_load_dwordx4 v[160:163], v16, s[44:47], s10 offen offset:0 nt
    s_waitcnt vmcnt(6)
    buffer_load_dwordx4 v[164:167], v16, s[44:47], s10 offen offset:256 nt
    s_waitcnt vmcnt(6)
    v_mov_b32 v9, 34
    ds_write_b32 v6, v9 offset:16
    s_add_u32 s10, s80, 0x188000
    buffer_load_dwordx4 v[168:171], v16, s[44:47], s10 offen offset:0 nt
    s_waitcnt vmcnt(6)
    buffer_load_dwordx4 v[172:175], v16, s[44:47], s10 offen offset:256 nt
    s_waitcnt vmcnt(6)
    s_add_u32 s10, s80, 0x1a0000
    buffer_load_dwordx4 v[176:179], v16, s[44:47], s10 offen offset:0 nt
    s_waitcnt vmcnt(6)
    buffer_load_dwordx4 v[180:183], v16, s[44:47], s10 offen offset:256 nt
    s_waitcnt vmcnt(6)
    s_add_u32 s10, s80, 0x1a8000
    buffer_load_dwordx4 v[184:187], v16, s[44:47], s10 offen offset:0 nt
    s_waitcnt vmcnt(6)
    buffer_load_dwordx4 v[188:191], v16, s[44:47], s10 offen offset:256 nt
    v_mov_b32 v9, 40
    ds_write_b32 v6, v9 offset:16
    s_mov_b32 s14, 0
L_spin1:
    ds_read_b128 v[24:27], v7 offset:32
    s_add_u32 s14, s14, 1
    s_waitcnt lgkmcnt(0)
    v_min3_u32 v1, v24, v25, v26
    v_min_u32 v1, v1, v27
    s_nop 0
    v_readfirstlane_b32 s10, v1
    s_cmp_ge_u32 s10, 1
    s_cbranch_scc1 L_got2
    s_cmp_gt_u32 s14, 2097152
    s_cbranch_scc1 L_exit
    s_sleep 1
    s_branch L_spin1
L_got2:
    ds_read_b128 v[24:27], v17 offset:0
    ds_read_b128 v[28:31], v17 offset:16
    ds_read_b128 v[32:35], v17 offset:32
    ds_read_b128 v[36:39], v17 offset:48
    ds_read_b128 v[56:59], v4 offset:64
    ds_read_b32 v60, v8 offset:64
    ds_read_b32 v2, v7 offset:0
    s_waitcnt lgkmcnt(0)
    v_readfirstlane_b32 s15, v2
    v_and_b32 v40, v24, v20
    v_and_b32 v41, v24, v21
    v_and_b32 v42, v24, v22
    v_and_b32 v43, v24, v23
    v_max3_f32 v56, v56, v57, v58
    v_max_f32 v56, v56, v59
    v_sub_f32 v56, v60, v56
    v_exp_f32 v56, v56
    v_and_b32 v44, v25, v20
    v_and_b32 v45, v25, v21
    v_and_b32 v46, v25, v22
    v_and_b32 v47, v25, v23
    v_mfma_f32_16x16x32_bf16 v[48:51], v[40:43], v[64:67], 0
    v_mfma_f32_16x16x32_bf16 v[52:55], v[40:43], v[68:71], 0
    v_and_b32 v40, v26, v20
    v_and_b32 v41, v26, v21
    v_and_b32 v42, v26, v22
    v_and_b32 v43, v26, v23
    v_mov_b32 v57, v56
    v_mfma_f32_16x16x32_bf16 v[48:51], v[44:47], v[72:75], v[48:51]
    v_mfma_f32_16x16x32_bf16 v[52:55], v[44:47], v[76:79], v[52:55]
    v_and_b32 v44, v27, v20
    v_and_b32 v45, v27, v21
    v_and_b32 v46, v27, v22
    v_and_b32 v47, v27, v23
    v_mfma_f32_16x16x32_bf16 v[48:51], v[40:43], v[80:83], v[48:51]
    v_mfma_f32_16x16x32_bf16 v[52:55], v[40:43], v[84:87], v[52:55]
    v_and_b32 v40, v28, v20
    v_and_b32 v41, v28, v21
    v_and_b32 v42, v28, v22
    v_and_b32 v43, v28, v23
    v_mfma_f32_16x16x32_bf16 v[48:51], v[44:47], v[88:91], v[48:51]
    v_mfma_f32_16x16x32_bf16 v[52:55], v[44:47], v[92:95], v[52:55]
    v_and_b32 v44, v29, v20
    v_and_b32 v45, v29, v21
    v_and_b32 v46, v29, v22
    v_and_b32 v47, v29, v23
    v_mfma_f32_16x16x32_bf16 v[48:51], v[40:43], v[96:99], v[48:51]
    v_mfma_f32_16x16x32_bf16 v[52:55], v[40:43], v[100:103], v[52:55]
    v_and_b32 v40, v30, v20
    v_and_b32 v41, v30, v21
    v_and_b32 v42, v30, v22
    v_and_b32 v43, v30, v23
    v_mfma_f32_16x16x32_bf16 v[48:51], v[44:47], v[104:107], v[48:51]
    v_mfma_f32_16x16x32_bf16 v[52:55], v[44:47], v[108:111], v[52:55]
    v_and_b32 v44, v31, v20
    v_and_b32 v45, v31, v21
    v_and_b32 v46, v31, v22
    v_and_b32 v47, v31, v23
    v_mfma_f32_16x16x32_bf16 v[48:51], v[40:43], v[112:115], v[48:51]
    v_mfma_f32_16x16x32_bf16 v[52:55], v[40:43], v[116:119], v[52:55]
    v_and_b32 v40, v32, v20
    v_and_b32 v41, v32, v21
    v_and_b32 v42, v32, v22
    v_and_b32 v43, v32, v23
    v_mfma_f32_16x16x32_bf16 v[48:51], v[44:47], v[120:123], v[48:51]
    v_mfma_f32_16x16x32_bf16 v[52:55], v[44:47], v[124:127], v[52:55]
    v_and_b32 v44, v33, v20
    v_and_b32 v45, v33, v21
    v_and_b32 v46, v33, v22
    v_and_b32 v47, v33, v23
    v_mfma_f32_16x16x32_bf16 v[48:51], v[40:43], v[128:131], v[48:51]
    v_mfma_f32_16x16x32_bf16 v[52:55], v[40:43], v[132:135], v[52:55]
    v_and_b32 v40, v34, v20
    v_and_b32 v41, v34, v21
    v_and_b32 v42, v34, v22
    v_and_b32 v43, v34, v23
    v_mfma_f32_16x16x32_bf16 v[48:51], v[44:47], v[136:139], v[48:51]
    v_mfma_f32_16x16x32_bf16 v[52:55], v[44:47], v[140:143], v[52:55]
    v_and_b32 v44, v35, v20
    v_and_b32 v45, v35, v21
    v_and_b32 v46, v35, v22
    v_and_b32 v47, v35, v23
    v_mfma_f32_16x16x32_bf16 v[48:51], v[40:43], v[144:147], v[48:51]
    v_mfma_f32_16x16x32_bf16 v[52:55], v[40:43], v[148:151], v[52:55]
    v_and_b32 v40, v36, v20
    v_and_b32 v41, v36, v21
    v_and_b32 v42, v36, v22
    v_and_b32 v43, v36, v23
    v_mfma_f32_16x16x32_bf16 v[48:51], v[44:47], v[152:155], v[48:51]
    v_mfma_f32_16x16x32_bf16 v[52:55], v[44:47], v[156:159], v[52:55]
    v_and_b32 v44, v37, v20
    v_and_b32 v45, v37, v21
    v_and_b32 v46, v37, v22
    v_and_b32 v47, v37, v23
    v_mfma_f32_16x16x32_bf16 v[48:51], v[40:43], v[160:163], v[48:51]
    s_waitcnt vmcnt(6)
    v_mfma_f32_16x16x32_bf16 v[52:55], v[40:43], v[164:167], v[52:55]
    v_and_b32 v40, v38, v20
    v_and_b32 v41, v38, v21
    v_and_b32 v42, v38, v22
    v_and_b32 v43, v38, v23
    s_waitcnt vmcnt(5)
    v_mfma_f32_16x16x32_bf16 v[48:51], v[44:47], v[168:171], v[48:51]
    s_waitcnt vmcnt(4)
    v_mfma_f32_16x16x32_bf16 v[52:55], v[44:47], v[172:175], v[52:55]
    v_and_b32 v44, v39, v20
    v_and_b32 v45, v39, v21
    v_and_b32 v46, v39, v22
    v_and_b32 v47, v39, v23
    s_waitcnt vmcnt(3)
    v_mfma_f32_16x16x32_bf16 v[48:51], v[40:43], v[176:179], v[48:51]
    s_waitcnt vmcnt(2)
    v_mfma_f32_16x16x32_bf16 v[52:55], v[40:43], v[180:183], v[52:55]
    s_waitcnt vmcnt(1)
    v_mfma_f32_16x16x32_bf16 v[48:51], v[44:47], v[184:187], v[48:51]
    s_waitcnt vmcnt(0)
    v_mfma_f32_16x16x32_bf16 v[52:55], v[44:47], v[188:191], v[52:55]
    s_nop 5
    v_pk_mul_f32 v[48:49], v[48:49], v[56:57]
    v_pk_mul_f32 v[50:51], v[50:51], v[56:57]
    ds_write_b128 v18, v[48:51] offset:0
    v_pk_mul_f32 v[52:53], v[52:53], v[56:57]
    v_pk_mul_f32 v[54:55], v[54:55], v[56:57]
    ds_write_b128 v18, v[52:55] offset:1024
    s_mov_b64 exec, 1
    ds_add_rtn_u32 v1, v7, v5 offset:4
    s_mov_b64 exec, -1
    ds_read_b128 v[64:67], v19 offset:0
    ds_read_b128 v[68:71], v19 offset:2048
    ds_read_b128 v[72:75], v19 offset:4096
    ds_read_b128 v[76:79], v19 offset:6144
    ds_read_b128 v[80:83], v19 offset:256
    ds_read_b128 v[84:87], v19 offset:2304
    ds_read_b128 v[88:91], v19 offset:4352
    ds_read_b128 v[92:95], v19 offset:6400
    s_waitcnt lgkmcnt(8)
    v_readfirstlane_b32 s10, v1
    s_cmp_eq_u32 s10, 3
    s_cbranch_scc0 L_exitL
    s_waitcnt lgkmcnt(4)
    v_pk_add_f32 v[64:65], v[64:65], v[68:69]
    v_pk_add_f32 v[72:73], v[72:73], v[76:77]
    v_pk_add_f32 v[66:67], v[66:67], v[70:71]
    v_pk_add_f32 v[74:75], v[74:75], v[78:79]
    v_pk_add_f32 v[64:65], v[64:65], v[72:73]
    v_pk_add_f32 v[66:67], v[66:67], v[74:75]
    v_cvt_pk_bf16_f32 v48, v64, v65
    v_cvt_pk_bf16_f32 v49, v66, v67
    v_min_u32 v48, -2, v48
    v_min_u32 v49, -2, v49
    s_waitcnt lgkmcnt(0)
    v_pk_add_f32 v[80:81], v[80:81], v[84:85]
    v_pk_add_f32 v[88:89], v[88:89], v[92:93]
    v_pk_add_f32 v[82:83], v[82:83], v[86:87]
    v_pk_add_f32 v[90:91], v[90:91], v[94:95]
    v_pk_add_f32 v[80:81], v[80:81], v[88:89]
    v_pk_add_f32 v[82:83], v[82:83], v[90:91]
    v_cvt_pk_bf16_f32 v50, v80, v81
    v_cvt_pk_bf16_f32 v51, v82, v83
    v_min_u32 v50, -2, v50
    v_min_u32 v51, -2, v51
    s_cmp_eq_u32 s15, 2
    s_cbranch_scc0 L_far3
    buffer_store_dwordx4 v[48:51], v3, s[48:51], s13 offen
L_st4:
    ds_write_b32 v7, v5 offset:8
L_exitL:
L_end0:
    s_endpgm
L_far3:
    buffer_store_dwordx4 v[48:51], v3, s[48:51], s13 offen sc1
    s_branch L_st4
.p2align 12
L_helper:
    v_lshrrev_b32 v12, 4, v0
    v_and_b32 v13, 15, v0
    v_mov_b32 v14, 0
    v_lshlrev_b32 v15, 4, v0
    v_bfe_u32 v1, v0, 2, 2
    v_lshl_add_u32 v10, v12, 3, v1
    v_and_b32 v11, 3, v0
    s_getreg_b32 s80, hwreg(HW_REG_XCC_ID, 0, 4)
    s_mov_b32 m0, 0x24000
    s_mul_i32 s13, s4, 7
    s_add_u32 s13, s13, s5
    s_waitcnt lgkmcnt(0)
    s_barrier
    s_sub_u32 s83, s13, 14
    s_mov_b32 s48, s38
    s_mov_b32 s49, s39
    s_mov_b32 s50, 0x200000
    s_mov_b32 s51, 0x20000
    s_mov_b32 s52, s16
    s_mov_b32 s53, s17
    s_mov_b32 s54, 0x700
    s_mov_b32 s55, 0x20000
    buffer_load_dwordx2 v[2:3], v14, s[48:51], 0 offen sc1
    s_cmp_eq_u32 s9, 0
    s_cbranch_scc1 L_q
    s_cmp_eq_u32 s9, 1
    s_cbranch_scc0 L_noclr
    s_cmp_lt_u32 s5, 21
    s_cbranch_scc0 L_noclr
    v_mov_b32 v28, -1
    v_mov_b32 v29, -1
    v_mov_b32 v30, -1
    v_mov_b32 v31, -1
    s_cmp_lt_u32 s5, 14
    s_cbranch_scc1 L_clrP
    s_mul_i32 s10, s83, 3584
    s_add_u32 s10, s10, 0x80000
    buffer_store_dwordx4 v[28:31], v15, s[48:51], s10 offen offset:0 sc1
    buffer_store_dwordx4 v[28:31], v15, s[48:51], s10 offen offset:1024 sc1
    buffer_store_dwordx4 v[28:31], v15, s[48:51], s10 offen offset:2048 sc1
    buffer_store_dwordx4 v[28:31], v15, s[48:51], s10 offen offset:2560 sc1
    s_branch L_clrd
L_clrP:
    v_lshrrev_b32 v1, 3, v0
    v_and_b32 v4, 7, v0
    v_lshlrev_b32 v4, 4, v4
    v_lshl_add_u32 v4, v1, 14, v4
    s_lshl_b32 s10, s2, 7
    s_add_u32 s10, s10, 0xc0000
    buffer_store_dwordx4 v[28:31], v4, s[48:51], s10 offen sc1
    s_mov_b64 exec, -1
L_clrd:
    s_lshl_b32 s10, s8, 4
    s_add_u32 s10, s10, 0x4000
    s_waitcnt vmcnt(0)
    v_add_u32 v2, 0x7f4a7c15, v2
    v_add_u32 v3, 0x9e3779b0, v3
    v_and_b32 v3, -16, v3
    s_mov_b64 exec, 1
    buffer_store_dwordx2 v[2:3], v14, s[48:51], s10 offen sc1
    s_mov_b64 exec, -1
    s_branch L_qdone
L_noclr:
    s_waitcnt vmcnt(0)
    v_add_u32 v2, 0x7f4a7c15, v2
    v_add_u32 v3, 0x9e3779b0, v3
    v_and_b32 v3, -16, v3
    s_branch L_qdone
L_q:
    buffer_load_dwordx4 v15, s[52:55], 0 offen lds
    s_mov_b32 exec_hi, 0xffff
    buffer_load_dwordx4 v15, s[52:55], 0 offen offset:1024 lds
    s_mov_b32 exec_hi, 0xffffff
    v_mov_b32 v20, 0x3f803f80
    v_mov_b32 v21, 0x3f803f80
    v_mov_b32 v22, 0x3f803f80
    v_mov_b32 v23, 0x3f803f80
    v_mov_b32 v24, 0
    v_mov_b32 v25, 0
    v_mov_b32 v26, 0
    v_mov_b32 v27, 0
    v_add_u32 v1, 0x24000, v15
    ds_write_b128 v1, v[20:23] offset:1792
    ds_write_b128 v1, v[24:27] offset:2688
    s_mov_b64 exec, -1
    v_mul_u32_u24 v1, 896, v11
    v_lshl_add_u32 v1, v12, 4, v1
    v_add_u32 v4, 0x24000, v1
    s_lshr_b32 s10, s81, 3
    s_lshl_b32 s11, s10, 6
    v_add_u32 v8, s11, v4
    v_mov_b32 v9, 0x24780
    s_cmp_ge_u32 s10, 2
    s_cselect_b64 vcc, -1, 0
    v_cndmask_b32 v9, v8, v9, vcc
    v_lshlrev_b32 v1, 7, v10
    v_lshl_add_u32 v1, v11, 3, v1
    v_add_u32 v16, 0x20000, v1
    s_waitcnt vmcnt(0)
    ds_read_b128 v[64:67], v4 offset:0
    ds_read_b128 v[68:71], v4 offset:64
    ds_read_b128 v[72:75], v4 offset:128
    ds_read_b128 v[76:79], v4 offset:192
    ds_read_b128 v[80:83], v4 offset:256
    ds_read_b128 v[84:87], v4 offset:320
    ds_read_b128 v[88:91], v4 offset:384
    ds_read_b128 v[92:95], v4 offset:448
    ds_read_b128 v[96:99], v4 offset:512
    ds_read_b128 v[100:103], v4 offset:576
    ds_read_b128 v[104:107], v4 offset:640
    ds_read_b128 v[108:111], v4 offset:704
    ds_read_b128 v[112:115], v4 offset:768
    ds_read_b128 v[116:119], v4 offset:832
    v_add_u32 v2, 0x7f4a7c15, v2
    v_add_u32 v3, 0x9e3779b0, v3
    v_and_b32 v3, -16, v3
    s_waitcnt lgkmcnt(13)
    v_mfma_f32_16x16x32_bf16 v[20:23], v[64:67], v[64:67], 0
    s_waitcnt lgkmcnt(12)
    v_mfma_f32_16x16x32_bf16 v[20:23], v[68:71], v[68:71], v[20:23]
    s_waitcnt lgkmcnt(11)
    v_mfma_f32_16x16x32_bf16 v[20:23], v[72:75], v[72:75], v[20:23]
    s_waitcnt lgkmcnt(10)
    v_mfma_f32_16x16x32_bf16 v[20:23], v[76:79], v[76:79], v[20:23]
    s_waitcnt lgkmcnt(9)
    v_mfma_f32_16x16x32_bf16 v[20:23], v[80:83], v[80:83], v[20:23]
    s_waitcnt lgkmcnt(8)
    v_mfma_f32_16x16x32_bf16 v[20:23], v[84:87], v[84:87], v[20:23]
    s_waitcnt lgkmcnt(7)
    v_mfma_f32_16x16x32_bf16 v[20:23], v[88:91], v[88:91], v[20:23]
    s_waitcnt lgkmcnt(6)
    v_mfma_f32_16x16x32_bf16 v[20:23], v[92:95], v[92:95], v[20:23]
    s_waitcnt lgkmcnt(5)
    v_mfma_f32_16x16x32_bf16 v[20:23], v[96:99], v[96:99], v[20:23]
    s_waitcnt lgkmcnt(4)
    v_mfma_f32_16x16x32_bf16 v[20:23], v[100:103], v[100:103], v[20:23]
    s_waitcnt lgkmcnt(3)
    v_mfma_f32_16x16x32_bf16 v[20:23], v[104:107], v[104:107], v[20:23]
    s_waitcnt lgkmcnt(2)
    v_mfma_f32_16x16x32_bf16 v[20:23], v[108:111], v[108:111], v[20:23]
    s_waitcnt lgkmcnt(1)
    v_mfma_f32_16x16x32_bf16 v[20:23], v[112:115], v[112:115], v[20:23]
    s_waitcnt lgkmcnt(0)
    v_mfma_f32_16x16x32_bf16 v[20:23], v[116:119], v[116:119], v[20:23]
    ds_read_b128 v[120:123], v8 offset:0
    ds_read_b128 v[124:127], v8 offset:256
    ds_read_b128 v[128:131], v8 offset:512
    ds_read_b128 v[132:135], v9 offset:768
    v_and_b32 v1, 1, v0
    v_cmp_eq_u32 vcc, 1, v1
    s_nop 1
    v_cndmask_b32 v20, v20, v21, vcc
    v_mul_f32 v44, 0x3b124925, v22
    v_mul_f32 v45, 0x3b124925, v20
    v_fma_f32 v45, -v44, v44, v45
    v_max_f32 v45, 0, v45
    v_add_f32 v45, 0x3727c5ac, v45
    v_rsq_f32 v45, v45
    s_mov_b32 s14, 0
L_spin5:
    ds_read_b128 v[24:27], v7 offset:16
    s_add_u32 s14, s14, 1
    s_waitcnt lgkmcnt(0)
    v_min3_u32 v1, v24, v25, v26
    v_min_u32 v1, v1, v27
    s_nop 0
    v_readfirstlane_b32 s10, v1
    s_cmp_ge_u32 s10, 1
    s_cbranch_scc1 L_got6
    s_cmp_gt_u32 s14, 2097152
    s_cbranch_scc1 L_exit
    s_sleep 1
    s_branch L_spin5
L_got6:
    ds_read_b64_tr_b16 v[136:137], v16 offset:0
    ds_read_b64_tr_b16 v[138:139], v16 offset:512
    ds_read_b64_tr_b16 v[140:141], v16 offset:32
    ds_read_b64_tr_b16 v[142:143], v16 offset:544
    ds_read_b64_tr_b16 v[144:145], v16 offset:64
    ds_read_b64_tr_b16 v[146:147], v16 offset:576
    ds_read_b64_tr_b16 v[148:149], v16 offset:96
    ds_read_b64_tr_b16 v[150:151], v16 offset:608
    s_waitcnt lgkmcnt(0)
    v_mfma_f32_16x16x32_bf16 v[24:27], v[136:139], v[120:123], 0
    v_mfma_f32_16x16x32_bf16 v[28:31], v[140:143], v[120:123], 0
    v_mfma_f32_16x16x32_bf16 v[32:35], v[144:147], v[120:123], 0
    v_mfma_f32_16x16x32_bf16 v[36:39], v[148:151], v[120:123], 0
    ds_read_b64_tr_b16 v[152:153], v16 offset:4096
    ds_read_b64_tr_b16 v[154:155], v16 offset:4608
    ds_read_b64_tr_b16 v[156:157], v16 offset:4128
    ds_read_b64_tr_b16 v[158:159], v16 offset:4640
    ds_read_b64_tr_b16 v[160:161], v16 offset:4160
    ds_read_b64_tr_b16 v[162:163], v16 offset:4672
    ds_read_b64_tr_b16 v[164:165], v16 offset:4192
    ds_read_b64_tr_b16 v[166:167], v16 offset:4704
    s_waitcnt lgkmcnt(0)
    v_mfma_f32_16x16x32_bf16 v[24:27], v[152:155], v[124:127], v[24:27]
    v_mfma_f32_16x16x32_bf16 v[28:31], v[156:159], v[124:127], v[28:31]
    v_mfma_f32_16x16x32_bf16 v[32:35], v[160:163], v[124:127], v[32:35]
    v_mfma_f32_16x16x32_bf16 v[36:39], v[164:167], v[124:127], v[36:39]
    ds_read_b64_tr_b16 v[168:169], v16 offset:8192
    ds_read_b64_tr_b16 v[170:171], v16 offset:8704
    ds_read_b64_tr_b16 v[172:173], v16 offset:8224
    ds_read_b64_tr_b16 v[174:175], v16 offset:8736
    ds_read_b64_tr_b16 v[176:177], v16 offset:8256
    ds_read_b64_tr_b16 v[178:179], v16 offset:8768
    ds_read_b64_tr_b16 v[180:181], v16 offset:8288
    ds_read_b64_tr_b16 v[182:183], v16 offset:8800
    s_waitcnt lgkmcnt(0)
    v_mfma_f32_16x16x32_bf16 v[24:27], v[168:171], v[128:131], v[24:27]
    v_mfma_f32_16x16x32_bf16 v[28:31], v[172:175], v[128:131], v[28:31]
    v_mfma_f32_16x16x32_bf16 v[32:35], v[176:179], v[128:131], v[32:35]
    v_mfma_f32_16x16x32_bf16 v[36:39], v[180:183], v[128:131], v[36:39]
    ds_read_b64_tr_b16 v[184:185], v16 offset:12288
    ds_read_b64_tr_b16 v[186:187], v16 offset:12800
    ds_read_b64_tr_b16 v[188:189], v16 offset:12320
    ds_read_b64_tr_b16 v[190:191], v16 offset:12832
    ds_read_b64_tr_b16 v[192:193], v16 offset:12352
    ds_read_b64_tr_b16 v[194:195], v16 offset:12864
    ds_read_b64_tr_b16 v[196:197], v16 offset:12384
    ds_read_b64_tr_b16 v[198:199], v16 offset:12896
    s_waitcnt lgkmcnt(0)
    v_mfma_f32_16x16x32_bf16 v[24:27], v[184:187], v[132:135], v[24:27]
    v_mfma_f32_16x16x32_bf16 v[28:31], v[188:191], v[132:135], v[28:31]
    v_mfma_f32_16x16x32_bf16 v[32:35], v[192:195], v[132:135], v[32:35]
    v_mfma_f32_16x16x32_bf16 v[36:39], v[196:199], v[132:135], v[36:39]
    v_lshrrev_b32 v1, 2, v13
    v_cmp_eq_u32 vcc, 1, v1
    s_nop 3
    v_cndmask_b32 v24, v24, v28, vcc
    v_cndmask_b32 v25, v25, v29, vcc
    v_cndmask_b32 v26, v26, v30, vcc
    v_cndmask_b32 v27, v27, v31, vcc
    v_cmp_eq_u32 vcc, 2, v1
    s_nop 1
    v_cndmask_b32 v24, v24, v32, vcc
    v_cndmask_b32 v25, v25, v33, vcc
    v_cndmask_b32 v26, v26, v34, vcc
    v_cndmask_b32 v27, v27, v35, vcc
    v_cmp_eq_u32 vcc, 3, v1
    s_nop 1
    v_cndmask_b32 v24, v24, v36, vcc
    v_cndmask_b32 v25, v25, v37, vcc
    v_cndmask_b32 v26, v26, v38, vcc
    v_cndmask_b32 v27, v27, v39, vcc
    v_mov_b32_dpp v32, v24 quad_perm:[2,2,2,2] row_mask:0xf bank_mask:0xf
    v_mov_b32_dpp v33, v25 quad_perm:[2,2,2,2] row_mask:0xf bank_mask:0xf
    v_mov_b32_dpp v34, v26 quad_perm:[2,2,2,2] row_mask:0xf bank_mask:0xf
    v_mov_b32_dpp v35, v27 quad_perm:[2,2,2,2] row_mask:0xf bank_mask:0xf
    v_fma_f32 v24, -v44, v32, v24
    v_fma_f32 v25, -v44, v33, v25
    v_fma_f32 v26, -v44, v34, v26
    v_fma_f32 v27, -v44, v35, v27
    v_mul_f32 v24, v24, v45
    v_mul_f32 v25, v25, v45
    v_mul_f32 v26, v26, v45
    v_mul_f32 v27, v27, v45
    v_mov_b32 v20, v2
    v_or_b32 v21, s80, v3
    v_cvt_pk_bf16_f32 v22, v24, v25
    v_cvt_pk_bf16_f32 v23, v26, v27
    v_lshlrev_b32 v1, 6, v1
    v_lshl_add_u32 v1, v12, 4, v1
    v_lshl_add_u32 v1, v11, 8, v1
    s_lshl_b32 s10, s4, 5
    s_add_u32 s10, s10, s81
    s_lshl_b32 s10, s10, 9
    s_add_u32 s10, s10, 0x20000
    s_mov_b32 exec_lo, 0x33333333
    s_mov_b32 exec_hi, 0x33333333
    buffer_store_dwordx4 v[20:23], v1, s[48:51], s10 offen
    s_xor_b32 s10, s10, 0x100000
    buffer_store_dwordx4 v[20:23], v1, s[48:51], s10 offen sc1
    s_mov_b64 exec, -1
    s_mov_b32 s14, 0
L_spin7:
    ds_read_b32 v1, v6 offset:16
    s_add_u32 s14, s14, 1
    s_waitcnt lgkmcnt(0)
    v_readfirstlane_b32 s10, v1
    s_cmp_ge_u32 s10, 2
    s_cbranch_scc1 L_got8
    s_cmp_gt_u32 s14, 2097152
    s_cbranch_scc1 L_exit
    s_sleep 1
    s_branch L_spin7
L_got8:
    v_lshlrev_b32 v1, 4, v13
    v_lshl_add_u32 v4, v12, 9, v1
    s_lshl_b32 s10, s4, 14
    s_lshl_b32 s11, s6, 8
    s_add_u32 s10, s10, s11
    s_add_u32 s10, s10, 0x20000
    s_add_u32 s11, s10, 4096
    s_add_u32 s12, s10, 8192
    s_add_u32 s13, s10, 12288
    s_mov_b32 s14, 0
L_qpoll:
    buffer_load_dwordx4 v[64:67], v4, s[48:51], s10 offen offset:0 sc1
    buffer_load_dwordx4 v[68:71], v4, s[48:51], s10 offen offset:2048 sc1
    buffer_load_dwordx4 v[72:75], v4, s[48:51], s11 offen offset:0 sc1
    buffer_load_dwordx4 v[76:79], v4, s[48:51], s11 offen offset:2048 sc1
    buffer_load_dwordx4 v[80:83], v4, s[48:51], s12 offen offset:0 sc1
    buffer_load_dwordx4 v[84:87], v4, s[48:51], s12 offen offset:2048 sc1
    buffer_load_dwordx4 v[88:91], v4, s[48:51], s13 offen offset:0 sc1
    buffer_load_dwordx4 v[92:95], v4, s[48:51], s13 offen offset:2048 sc1
    s_add_u32 s14, s14, 1
    s_cmp_gt_u32 s14, 262144
    s_cbranch_scc1 L_exit
    s_cmp_eq_u32 s14, 3
    s_cselect_b32 s26, 0x100000, 0
    s_xor_b32 s10, s10, s26
    s_xor_b32 s11, s11, s26
    s_xor_b32 s12, s12, s26
    s_xor_b32 s13, s13, s26
    v_mov_b32 v32, 0
    v_mov_b32 v33, 0
    s_waitcnt vmcnt(0)
    v_xor_b32 v34, v64, v2
    v_xor_b32 v35, v65, v21
    v_or_b32 v32, v32, v34
    v_or_b32 v33, v33, v35
    v_xor_b32 v34, v68, v2
    v_xor_b32 v35, v69, v21
    v_or_b32 v32, v32, v34
    v_or_b32 v33, v33, v35
    v_xor_b32 v34, v72, v2
    v_xor_b32 v35, v73, v21
    v_or_b32 v32, v32, v34
    v_or_b32 v33, v33, v35
    v_xor_b32 v34, v76, v2
    v_xor_b32 v35, v77, v21
    v_or_b32 v32, v32, v34
    v_or_b32 v33, v33, v35
    v_xor_b32 v34, v80, v2
    v_xor_b32 v35, v81, v21
    v_or_b32 v32, v32, v34
    v_or_b32 v33, v33, v35
    v_xor_b32 v34, v84, v2
    v_xor_b32 v35, v85, v21
    v_or_b32 v32, v32, v34
    v_or_b32 v33, v33, v35
    v_xor_b32 v34, v88, v2
    v_xor_b32 v35, v89, v21
    v_or_b32 v32, v32, v34
    v_or_b32 v33, v33, v35
    v_xor_b32 v34, v92, v2
    v_xor_b32 v35, v93, v21
    v_or_b32 v32, v32, v34
    v_or_b32 v33, v33, v35
    v_and_or_b32 v32, v33, -16, v32
    v_cmp_ne_u32 vcc, 0, v32
    s_and_b64 exec, exec, vcc
    s_cbranch_scc1 L_qpoll
    s_mov_b64 exec, -1
    v_lshlrev_b32 v1, 3, v0
    v_add_u32 v1, 0x24e00, v1
    ds_write_b64 v1, v[66:67] offset:0
    ds_write_b64 v1, v[70:71] offset:528
    ds_write_b64 v1, v[74:75] offset:1056
    ds_write_b64 v1, v[78:79] offset:1584
    ds_write_b64 v1, v[82:83] offset:2112
    ds_write_b64 v1, v[86:87] offset:2640
    ds_write_b64 v1, v[90:91] offset:3168
    ds_write_b64 v1, v[94:95] offset:3696
    v_cmp_ne_u32 vcc, 0, v33
    s_cmp_eq_u64 vcc, 0
    s_cselect_b32 s15, 2, 1
    v_mov_b32 v1, s15
    ds_write_b32 v7, v1 offset:0
    v_mov_b32 v28, -1
    v_mov_b32 v29, -1
    v_mov_b32 v30, -1
    v_mov_b32 v31, -1
    v_lshlrev_b32 v4, 8, v0
    s_lshr_b32 s13, s8, 4
    s_lshl_b32 s13, s13, 14
    s_lshl4_add_u32 s13, s7, s13
    s_add_u32 s13, s13, 0x40000
    s_cmp_eq_u32 s15, 2
    s_cbranch_scc0 L_far9
    buffer_store_dwordx4 v[28:31], v4, s[48:51], s13 offen
L_st10:
L_qdone:
    s_mov_b32 s14, 0
L_spin11:
    ds_read_b32 v1, v7 offset:0
    s_add_u32 s14, s14, 1
    s_waitcnt lgkmcnt(0)
    v_readfirstlane_b32 s15, v1
    s_cmp_ge_u32 s15, 1
    s_cbranch_scc1 L_got12
    s_cmp_gt_u32 s14, 2097152
    s_cbranch_scc1 L_exit
    s_sleep 1
    s_branch L_spin11
L_got12:
    v_bfe_u32 v1, v0, 2, 1
    v_lshl_add_u32 v1, v11, 1, v1
    v_mul_u32_u24 v1, 528, v1
    v_lshl_add_u32 v1, v12, 4, v1
    v_add_u32 v4, 0x24e00, v1
    ds_read_b128 v[64:67], v4 offset:0
    ds_read_b128 v[68:71], v4 offset:64
    ds_read_b128 v[72:75], v4 offset:128
    ds_read_b128 v[76:79], v4 offset:192
    ds_read_b128 v[80:83], v4 offset:256
    ds_read_b128 v[84:87], v4 offset:320
    ds_read_b128 v[88:91], v4 offset:384
    ds_read_b128 v[92:95], v4 offset:448
    s_lshl_b32 s80, s9, 15
    v_xor_b32 v1, v12, v13
    v_lshlrev_b32 v1, 4, v1
    v_lshl_add_u32 v1, v13, 9, v1
    v_add_u32 v16, s80, v1
    v_xor_b32 v17, 64, v16
    v_xor_b32 v18, 128, v16
    v_xor_b32 v19, 192, v16
    s_mov_b32 s14, 0
L_spin13:
    ds_read_b32 v1, v6 offset:16
    s_add_u32 s14, s14, 1
    s_waitcnt lgkmcnt(0)
    v_readfirstlane_b32 s10, v1
    s_cmp_ge_u32 s10, 13
    s_cbranch_scc1 L_got14
    s_cmp_gt_u32 s14, 2097152
    s_cbranch_scc1 L_exit
    s_sleep 1
    s_branch L_spin13
L_got14:
    ds_read_b128 v[96:99], v16 offset:0
    ds_read_b128 v[100:103], v16 offset:8192
    ds_read_b128 v[104:107], v16 offset:16384
    ds_read_b128 v[108:111], v16 offset:24576
    ds_read_b128 v[112:115], v17 offset:0
    ds_read_b128 v[116:119], v17 offset:8192
    ds_read_b128 v[120:123], v17 offset:16384
    ds_read_b128 v[124:127], v17 offset:24576
    ds_read_b128 v[128:131], v18 offset:0
    ds_read_b128 v[132:135], v18 offset:8192
    ds_read_b128 v[136:139], v18 offset:16384
    ds_read_b128 v[140:143], v18 offset:24576
    ds_read_b128 v[144:147], v19 offset:0
    s_waitcnt lgkmcnt(12)
    v_mfma_f32_16x16x32_bf16 v[20:23], v[64:67], v[96:99], 0
    ds_read_b128 v[148:151], v19 offset:8192
    s_waitcnt lgkmcnt(12)
    v_mfma_f32_16x16x32_bf16 v[24:27], v[64:67], v[100:103], 0
    ds_read_b128 v[152:155], v19 offset:16384
    s_waitcnt lgkmcnt(12)
    v_mfma_f32_16x16x32_bf16 v[28:31], v[64:67], v[104:107], 0
    ds_read_b128 v[156:159], v19 offset:24576
    s_waitcnt lgkmcnt(12)
    v_mfma_f32_16x16x32_bf16 v[32:35], v[64:67], v[108:111], 0
    ds_read_b128 v[160:163], v16 offset:256
    s_waitcnt lgkmcnt(12)
    v_mfma_f32_16x16x32_bf16 v[20:23], v[68:71], v[112:115], v[20:23]
    ds_read_b128 v[164:167], v16 offset:8448
    s_waitcnt lgkmcnt(12)
    v_mfma_f32_16x16x32_bf16 v[24:27], v[68:71], v[116:119], v[24:27]
    ds_read_b128 v[168:171], v16 offset:16640
    s_waitcnt lgkmcnt(12)
    v_mfma_f32_16x16x32_bf16 v[28:31], v[68:71], v[120:123], v[28:31]
    ds_read_b128 v[172:175], v16 offset:24832
    s_waitcnt lgkmcnt(12)
    v_mfma_f32_16x16x32_bf16 v[32:35], v[68:71], v[124:127], v[32:35]
    ds_read_b128 v[176:179], v17 offset:256
    s_waitcnt lgkmcnt(12)
    v_mfma_f32_16x16x32_bf16 v[20:23], v[72:75], v[128:131], v[20:23]
    ds_read_b128 v[180:183], v17 offset:8448
    s_waitcnt lgkmcnt(12)
    v_mfma_f32_16x16x32_bf16 v[24:27], v[72:75], v[132:135], v[24:27]
    ds_read_b128 v[184:187], v17 offset:16640
    s_waitcnt lgkmcnt(12)
    v_mfma_f32_16x16x32_bf16 v[28:31], v[72:75], v[136:139], v[28:31]
    ds_read_b128 v[188:191], v17 offset:24832
    s_waitcnt lgkmcnt(12)
    v_mfma_f32_16x16x32_bf16 v[32:35], v[72:75], v[140:143], v[32:35]
    ds_read_b128 v[192:195], v18 offset:256
    s_waitcnt lgkmcnt(12)
    v_mfma_f32_16x16x32_bf16 v[20:23], v[76:79], v[144:147], v[20:23]
    ds_read_b128 v[196:199], v18 offset:8448
    s_waitcnt lgkmcnt(12)
    v_mfma_f32_16x16x32_bf16 v[24:27], v[76:79], v[148:151], v[24:27]
    ds_read_b128 v[200:203], v18 offset:16640
    s_waitcnt lgkmcnt(12)
    v_mfma_f32_16x16x32_bf16 v[28:31], v[76:79], v[152:155], v[28:31]
    ds_read_b128 v[204:207], v18 offset:24832
    s_waitcnt lgkmcnt(12)
    v_mfma_f32_16x16x32_bf16 v[32:35], v[76:79], v[156:159], v[32:35]
    ds_read_b128 v[208:211], v19 offset:256
    s_waitcnt lgkmcnt(12)
    v_mfma_f32_16x16x32_bf16 v[20:23], v[80:83], v[160:163], v[20:23]
    ds_read_b128 v[212:215], v19 offset:8448
    s_waitcnt lgkmcnt(12)
    v_mfma_f32_16x16x32_bf16 v[24:27], v[80:83], v[164:167], v[24:27]
    ds_read_b128 v[216:219], v19 offset:16640
    s_waitcnt lgkmcnt(12)
    v_mfma_f32_16x16x32_bf16 v[28:31], v[80:83], v[168:171], v[28:31]
    ds_read_b128 v[220:223], v19 offset:24832
    s_waitcnt lgkmcnt(12)
    v_mfma_f32_16x16x32_bf16 v[32:35], v[80:83], v[172:175], v[32:35]
    s_waitcnt lgkmcnt(11)
    v_mfma_f32_16x16x32_bf16 v[20:23], v[84:87], v[176:179], v[20:23]
    s_waitcnt lgkmcnt(10)
    v_mfma_f32_16x16x32_bf16 v[24:27], v[84:87], v[180:183], v[24:27]
    s_waitcnt lgkmcnt(9)
    v_mfma_f32_16x16x32_bf16 v[28:31], v[84:87], v[184:187], v[28:31]
    s_waitcnt lgkmcnt(8)
    v_mfma_f32_16x16x32_bf16 v[32:35], v[84:87], v[188:191], v[32:35]
    s_waitcnt lgkmcnt(7)
    v_mfma_f32_16x16x32_bf16 v[20:23], v[88:91], v[192:195], v[20:23]
    s_waitcnt lgkmcnt(6)
    v_mfma_f32_16x16x32_bf16 v[24:27], v[88:91], v[196:199], v[24:27]
    s_waitcnt lgkmcnt(5)
    v_mfma_f32_16x16x32_bf16 v[28:31], v[88:91], v[200:203], v[28:31]
    s_waitcnt lgkmcnt(4)
    v_mfma_f32_16x16x32_bf16 v[32:35], v[88:91], v[204:207], v[32:35]
    s_waitcnt lgkmcnt(3)
    v_mfma_f32_16x16x32_bf16 v[20:23], v[92:95], v[208:211], v[20:23]
    s_waitcnt lgkmcnt(2)
    v_mfma_f32_16x16x32_bf16 v[24:27], v[92:95], v[212:215], v[24:27]
    s_waitcnt lgkmcnt(1)
    v_mfma_f32_16x16x32_bf16 v[28:31], v[92:95], v[216:219], v[28:31]
    s_waitcnt lgkmcnt(0)
    v_mfma_f32_16x16x32_bf16 v[32:35], v[92:95], v[220:223], v[32:35]
    s_mov_b32 vcc_lo, 0
    s_mov_b32 vcc_hi, -1
    v_and_b32 v1, 1, v12
    v_lshlrev_b32 v8, 10, v1
    v_lshl_add_u32 v9, v1, 4, v6
    v_lshlrev_b32 v1, 8, v1
    v_lshl_add_u32 v1, v11, 6, v1
    v_and_b32 v4, 12, v0
    v_add_u32 v1, v1, v4
    v_lshrrev_b32 v4, 5, v0
    v_lshl_add_u32 v1, v4, 4, v1
    s_lshl_b32 s10, s9, 9
    s_add_u32 s10, s10, 0x25f00
    v_add_u32 v4, s10, v1
    v_cndmask_b32 v20, v20, v24, vcc
    v_cndmask_b32 v28, v28, v32, vcc
    v_cndmask_b32 v21, v21, v25, vcc
    v_cndmask_b32 v29, v29, v33, vcc
    v_cndmask_b32 v22, v22, v26, vcc
    v_cndmask_b32 v30, v30, v34, vcc
    v_cndmask_b32 v23, v23, v27, vcc
    v_cndmask_b32 v31, v31, v35, vcc
    v_add_f32 v20, v20, v21
    v_add_f32 v22, v22, v23
    v_add_f32 v28, v28, v29
    v_add_f32 v30, v30, v31
    v_add_f32 v20, v20, v22
    v_add_f32 v21, v28, v30
    v_mul_f32 v20, 0x3db8aa3b, v20
    v_mul_f32 v21, 0x3db8aa3b, v21
    v_max_f32 v24, v20, v21
    s_nop 1
    v_max_f32_dpp v24, v24, v24 row_ror:8 row_mask:0xf bank_mask:0xf
    s_nop 1
    v_max_f32_dpp v24, v24, v24 row_ror:4 row_mask:0xf bank_mask:0xf
    s_nop 1
    v_max_f32_dpp v24, v24, v24 row_ror:2 row_mask:0xf bank_mask:0xf
    s_nop 1
    v_max_f32_dpp v24, v24, v24 row_ror:1 row_mask:0xf bank_mask:0xf
    v_mov_b32 v28, v24
    s_nop 1
    v_permlane32_swap_b32 v24, v28
    v_max_f32 v24, v24, v28
    v_sub_f32 v20, v20, v24
    v_sub_f32 v21, v21, v24
    v_exp_f32 v20, v20
    v_exp_f32 v21, v21
    ds_write_b32 v9, v24 offset:64
    v_add_f32 v25, v20, v21
    v_cvt_pk_bf16_f32 v20, v20, v20
    v_cvt_pk_bf16_f32 v21, v21, v21
    ds_write_b32 v4, v20
    ds_write_b32 v4, v21 offset:32
    s_waitcnt vmcnt(0)
    ds_write_b32 v6, v5 offset:32
    v_add_f32_dpp v25, v25, v25 row_ror:8 row_mask:0xf bank_mask:0xf
    s_nop 1
    v_add_f32_dpp v25, v25, v25 row_ror:4 row_mask:0xf bank_mask:0xf
    s_nop 1
    v_add_f32_dpp v25, v25, v25 row_ror:2 row_mask:0xf bank_mask:0xf
    s_nop 1
    v_add_f32_dpp v25, v25, v25 row_ror:1 row_mask:0xf bank_mask:0xf
    v_mov_b32 v28, v25
    s_nop 1
    v_permlane32_swap_b32 v25, v28
    v_add_f32 v25, v25, v28
    v_mov_b32 v22, v2
    v_mov_b32 v23, v3
    s_lshr_b32 s10, s8, 4
    s_lshl_b32 s10, s10, 11
    s_lshl2_add_u32 s11, s7, s9
    s_lshl4_add_u32 s10, s11, s10
    s_add_u32 s10, s10, 0x10000
    s_mov_b64 exec, 0x10001
    s_cmp_eq_u32 s15, 2
    s_cbranch_scc0 L_far15
    buffer_store_dwordx4 v[22:25], v8, s[48:51], s10 offen
L_st16:
    s_mov_b64 exec, -1
    s_mov_b32 s60, s24
    s_mov_b32 s61, s25
    s_mov_b32 s62, 0x380000
    s_mov_b32 s63, 0x20000
    s_mov_b32 m0, s80
    v_lshrrev_b32 v8, 2, v0
    v_lshlrev_b32 v1, 6, v10
    v_lshl_add_u32 v1, v11, 3, v1
    v_add_u32 v16, s80, v1
    s_mul_i32 s10, s4, 458752
    v_mul_u32_u24 v1, 458624, v0
    s_mov_b64 exec, 3
    buffer_load_dword v219, v1, s[60:63], s10 offen
    s_mov_b64 exec, -1
    s_cmp_lt_u32 s5, 14
    s_cbranch_scc1 L_wo
    s_mov_b32 s64, s28
    s_mov_b32 s65, s29
    s_mov_b32 s66, 0x188000
    s_mov_b32 s67, 0x20000
    s_mov_b32 s68, s30
    s_mov_b32 s69, s31
    s_mov_b32 s70, 0x188000
    s_mov_b32 s71, 0x20000
    s_mov_b32 s72, s32
    s_mov_b32 s73, s33
    s_mov_b32 s74, 0x188000
    s_mov_b32 s75, 0x20000
    v_mul_u32_u24 v1, 1605504, v0
    s_mov_b64 exec, 3
    buffer_load_dword v216, v1, s[64:67], 0 offen
    buffer_load_dword v217, v1, s[68:71], 0 offen
    buffer_load_dword v218, v1, s[72:75], 0 offen
    s_mov_b64 exec, -1
    s_cmp_lt_u32 s5, 21
    s_cbranch_scc1 L_ffn
    s_branch L_final
L_far9:
    buffer_store_dwordx4 v[28:31], v4, s[48:51], s13 offen sc1
    s_branch L_st10
L_far15:
    buffer_store_dwordx4 v[22:25], v8, s[48:51], s10 offen sc1
    s_branch L_st16
.p2align 12
L_wo:
    s_mov_b32 s14, 0
L_spin17:
    ds_read_b32 v1, v6 offset:16
    s_add_u32 s14, s14, 1
    s_waitcnt lgkmcnt(0)
    v_readfirstlane_b32 s10, v1
    s_cmp_ge_u32 s10, 34
    s_cbranch_scc1 L_got18
    s_cmp_gt_u32 s14, 2097152
    s_cbranch_scc1 L_exit
    s_sleep 1
    s_branch L_spin17
L_got18:
    s_lshl_b32 s11, s5, 6
    s_or_b32 s10, s4, s9
    s_cselect_b32 s11, 0x10000, s11
    v_lshrrev_b32 v1, 5, v0
    v_mul_u32_u24 v1, 896, v1
    v_and_b32 v4, 31, v0
    v_lshl_add_u32 v1, v4, 1, v1
    buffer_load_ushort v38, v1, s[52:55], s11 offen
    s_lshr_b32 s11, s9, 1
    s_lshl2_add_u32 s10, s4, s11
    s_lshl_b32 s10, s10, 10
    s_add_u32 s10, s10, 0x10000
    s_mov_b32 s14, 0
L_stpoll:
    buffer_load_dwordx4 v[28:31], v15, s[48:51], s10 offen sc1
    buffer_load_dwordx4 v[32:35], v15, s[48:51], s10 offen offset:2048 sc1
    s_add_u32 s14, s14, 1
    s_cmp_gt_u32 s14, 262144
    s_cbranch_scc1 L_exit
    s_waitcnt vmcnt(0)
    v_xor_b32 v28, v28, v2
    v_xor_b32 v29, v29, v3
    v_xor_b32 v32, v32, v2
    v_xor_b32 v33, v33, v3
    v_or_b32 v28, v28, v29
    v_or3_b32 v28, v28, v32, v33
    v_cmp_ne_u32 vcc, 0, v28
    s_and_b64 exec, exec, vcc
    s_cbranch_scc1 L_stpoll
    s_mov_b64 exec, -1
    v_max_f32_dpp v24, v30, v30 quad_perm:[1,0,3,2] row_mask:0xf bank_mask:0xf
    v_max_f32_dpp v25, v34, v34 quad_perm:[1,0,3,2] row_mask:0xf bank_mask:0xf
    s_nop 0
    v_max_f32_dpp v24, v24, v24 quad_perm:[2,3,0,1] row_mask:0xf bank_mask:0xf
    v_max_f32_dpp v25, v25, v25 quad_perm:[2,3,0,1] row_mask:0xf bank_mask:0xf
    v_mov_b32 v26, v24
    v_mov_b32 v27, v25
    s_nop 0
    v_max_f32_dpp v26, v26, v26 row_ror:8 row_mask:0xf bank_mask:0xf
    v_max_f32_dpp v27, v27, v27 row_ror:8 row_mask:0xf bank_mask:0xf
    s_nop 0
    v_max_f32_dpp v26, v26, v26 row_ror:4 row_mask:0xf bank_mask:0xf
    v_max_f32_dpp v27, v27, v27 row_ror:4 row_mask:0xf bank_mask:0xf
    v_mov_b32 v28, v26
    v_mov_b32 v29, v27
    s_nop 0
    v_permlane16_swap_b32 v26, v28
    v_permlane16_swap_b32 v27, v29
    v_max_f32 v26, v26, v28
    v_max_f32 v27, v27, v29
    v_mov_b32 v28, v26
    v_mov_b32 v29, v27
    s_nop 0
    v_permlane32_swap_b32 v26, v28
    v_permlane32_swap_b32 v27, v29
    v_max_f32 v26, v26, v28
    v_max_f32 v27, v27, v29
    v_sub_f32 v30, v30, v26
    v_sub_f32 v34, v34, v27
    v_sub_f32 v24, v24, v26
    v_sub_f32 v25, v25, v27
    v_exp_f32 v30, v30
    v_exp_f32 v34, v34
    v_exp_f32 v24, v24
    v_exp_f32 v25, v25
    v_mul_f32 v31, v31, v30
    v_mul_f32 v35, v35, v34
    s_nop 0
    v_add_f32_dpp v31, v31, v31 row_ror:8 row_mask:0xf bank_mask:0xf
    v_add_f32_dpp v35, v35, v35 row_ror:8 row_mask:0xf bank_mask:0xf
    s_nop 0
    v_add_f32_dpp v31, v31, v31 row_ror:4 row_mask:0xf bank_mask:0xf
    v_add_f32_dpp v35, v35, v35 row_ror:4 row_mask:0xf bank_mask:0xf
    s_nop 0
    v_add_f32_dpp v31, v31, v31 row_ror:2 row_mask:0xf bank_mask:0xf
    v_add_f32_dpp v35, v35, v35 row_ror:2 row_mask:0xf bank_mask:0xf
    s_nop 0
    v_add_f32_dpp v31, v31, v31 row_ror:1 row_mask:0xf bank_mask:0xf
    v_add_f32_dpp v35, v35, v35 row_ror:1 row_mask:0xf bank_mask:0xf
    v_mov_b32 v28, v31
    v_mov_b32 v29, v35
    s_nop 0
    v_permlane16_swap_b32 v31, v28
    v_permlane16_swap_b32 v35, v29
    v_add_f32 v31, v31, v28
    v_add_f32 v35, v35, v29
    v_mov_b32 v28, v31
    v_mov_b32 v29, v35
    s_nop 0
    v_permlane32_swap_b32 v31, v28
    v_permlane32_swap_b32 v35, v29
    v_add_f32 v31, v31, v28
    v_add_f32 v35, v35, v29
    v_rcp_f32 v31, v31
    v_rcp_f32 v35, v35
    v_lshlrev_b32 v38, 16, v38
    v_mul_f32 v24, v24, v31
    v_mul_f32 v25, v25, v35
    s_nop 0
    v_mov_b32_dpp v40, v24 row_newbcast:0 row_mask:0xf bank_mask:0xf
    v_mov_b32_dpp v41, v24 row_newbcast:4 row_mask:0xf bank_mask:0xf
    v_mov_b32_dpp v42, v24 row_newbcast:8 row_mask:0xf bank_mask:0xf
    v_mov_b32_dpp v43, v24 row_newbcast:12 row_mask:0xf bank_mask:0xf
    v_mov_b32_dpp v44, v25 row_newbcast:0 row_mask:0xf bank_mask:0xf
    v_mov_b32_dpp v45, v25 row_newbcast:4 row_mask:0xf bank_mask:0xf
    v_mov_b32_dpp v46, v25 row_newbcast:8 row_mask:0xf bank_mask:0xf
    v_mov_b32_dpp v47, v25 row_newbcast:12 row_mask:0xf bank_mask:0xf
    s_lshl_b32 s12, s9, 8
    s_add_u32 s12, s12, 0x22000
    v_lshlrev_b32 v9, 2, v0
    v_add_u32 v36, s12, v9
    v_lshlrev_b32 v37, 4, v13
    v_add_u32 v37, 0x22000, v37
    v_lshlrev_b32 v1, 3, v13
    v_lshl_add_u32 v9, v12, 14, v1
    v_mul_u32_u24 v17, 896, v8
    v_lshl_add_u32 v17, v11, 4, v17
    s_lshl2_add_u32 s12, s4, s9
    s_mul_i32 s12, s12, 114688
    s_lshl_b32 s11, s5, 6
    s_add_u32 s12, s12, s11
    s_lshl_b32 s13, s2, 7
    s_add_u32 s13, s13, 0xc0000
    s_add_u32 s28, s13, 0x10000
    s_mov_b32 s14, 0
L_spin19:
    ds_read_b32 v1, v6 offset:16
    s_add_u32 s14, s14, 1
    s_waitcnt lgkmcnt(0)
    v_readfirstlane_b32 s10, v1
    s_cmp_ge_u32 s10, 40
    s_cbranch_scc1 L_got20
    s_cmp_gt_u32 s14, 2097152
    s_cbranch_scc1 L_exit
    s_sleep 1
    s_branch L_spin19
L_got20:
    s_lshl2_add_u32 s10, s8, s9
    s_mul_i32 s10, s10, 3584
    v_lshlrev_b32 v1, 7, v0
    s_mov_b64 exec, 0xfffffff
    buffer_load_dword v220, v1, s[60:63], s10 offen
    s_mov_b64 exec, -1
    s_mov_b32 s14, 0
L_spin21:
    ds_read_b128 v[24:27], v7 offset:16
    s_add_u32 s14, s14, 1
    s_waitcnt lgkmcnt(0)
    v_min3_u32 v1, v24, v25, v26
    v_min_u32 v1, v1, v27
    s_nop 0
    v_readfirstlane_b32 s10, v1
    s_cmp_ge_u32 s10, 40
    s_cbranch_scc1 L_got22
    s_cmp_gt_u32 s14, 2097152
    s_cbranch_scc1 L_exit
    s_sleep 1
    s_branch L_spin21
L_got22:
    buffer_load_dwordx4 v17, s[60:63], s12 offen lds
    s_add_u32 m0, m0, 1024
    s_add_u32 s12, s12, 14336
    buffer_load_dwordx4 v17, s[60:63], s12 offen lds
    s_add_u32 m0, m0, 1024
    s_add_u32 s12, s12, 14336
    buffer_load_dwordx4 v17, s[60:63], s12 offen lds
    s_add_u32 m0, m0, 1024
    s_add_u32 s12, s12, 14336
    buffer_load_dwordx4 v17, s[60:63], s12 offen lds
    s_add_u32 m0, m0, 1024
    s_add_u32 s12, s12, 14336
    buffer_load_dwordx4 v17, s[60:63], s12 offen lds
    s_add_u32 m0, m0, 1024
    s_add_u32 s12, s12, 14336
    buffer_load_dwordx4 v17, s[60:63], s12 offen lds
    s_add_u32 m0, m0, 1024
    s_add_u32 s12, s12, 14336
    buffer_load_dwordx4 v17, s[60:63], s12 offen lds
    s_add_u32 m0, m0, 1024
    s_add_u32 s12, s12, 14336
    buffer_load_dwordx4 v17, s[60:63], s12 offen lds
    s_add_u32 m0, m0, 1024
    s_lshl3_add_u32 s10, s4, s9
    s_lshl_b32 s10, s10, 12
    s_add_u32 s10, s10, 0x40000
    s_add_u32 s11, s10, 16384
    s_mov_b32 s14, 0
L_spin23:
    ds_read_b32 v1, v7 offset:8
    s_add_u32 s14, s14, 1
    s_waitcnt lgkmcnt(0)
    v_readfirstlane_b32 s12, v1
    s_cmp_ge_u32 s12, 1
    s_cbranch_scc1 L_got24
    s_cmp_gt_u32 s14, 2097152
    s_cbranch_scc1 L_exit
    s_sleep 1
    s_branch L_spin23
L_got24:
    buffer_load_dwordx4 v[96:99], v15, s[48:51], s10 offen offset:0 sc1
    buffer_load_dwordx4 v[100:103], v15, s[48:51], s10 offen offset:1024 sc1
    buffer_load_dwordx4 v[104:107], v15, s[48:51], s10 offen offset:2048 sc1
    buffer_load_dwordx4 v[108:111], v15, s[48:51], s10 offen offset:3072 sc1
    buffer_load_dwordx4 v[112:115], v15, s[48:51], s11 offen offset:0 sc1
    buffer_load_dwordx4 v[116:119], v15, s[48:51], s11 offen offset:1024 sc1
    buffer_load_dwordx4 v[120:123], v15, s[48:51], s11 offen offset:2048 sc1
    buffer_load_dwordx4 v[124:127], v15, s[48:51], s11 offen offset:3072 sc1
    s_waitcnt vmcnt(14)
    ds_read_b64_tr_b16 v[64:65], v16 offset:0
    ds_read_b64_tr_b16 v[66:67], v16 offset:256
    ds_read_b64_tr_b16 v[68:69], v16 offset:32
    ds_read_b64_tr_b16 v[70:71], v16 offset:288
    s_waitcnt vmcnt(12)
    ds_read_b64_tr_b16 v[72:73], v16 offset:2048
    ds_read_b64_tr_b16 v[74:75], v16 offset:2304
    ds_read_b64_tr_b16 v[76:77], v16 offset:2080
    ds_read_b64_tr_b16 v[78:79], v16 offset:2336
    s_waitcnt vmcnt(10)
    ds_read_b64_tr_b16 v[80:81], v16 offset:4096
    ds_read_b64_tr_b16 v[82:83], v16 offset:4352
    ds_read_b64_tr_b16 v[84:85], v16 offset:4128
    ds_read_b64_tr_b16 v[86:87], v16 offset:4384
    s_waitcnt lgkmcnt(4)
    s_waitcnt vmcnt(8)
    ds_read_b64_tr_b16 v[88:89], v16 offset:6144
    ds_read_b64_tr_b16 v[90:91], v16 offset:6400
    ds_read_b64_tr_b16 v[92:93], v16 offset:6176
    ds_read_b64_tr_b16 v[94:95], v16 offset:6432
    s_mov_b32 s14, 0
    s_waitcnt lgkmcnt(0)
    s_branch L_omid
L_oboth:
    buffer_load_dwordx4 v[96:99], v15, s[48:51], s10 offen offset:0 sc1
    buffer_load_dwordx4 v[100:103], v15, s[48:51], s10 offen offset:1024 sc1
    buffer_load_dwordx4 v[104:107], v15, s[48:51], s10 offen offset:2048 sc1
    buffer_load_dwordx4 v[108:111], v15, s[48:51], s10 offen offset:3072 sc1
    buffer_load_dwordx4 v[112:115], v15, s[48:51], s11 offen offset:0 sc1
    buffer_load_dwordx4 v[116:119], v15, s[48:51], s11 offen offset:1024 sc1
    buffer_load_dwordx4 v[120:123], v15, s[48:51], s11 offen offset:2048 sc1
    buffer_load_dwordx4 v[124:127], v15, s[48:51], s11 offen offset:3072 sc1
    s_add_u32 s14, s14, 1
    s_cmp_gt_u32 s14, 262144
    s_cbranch_scc1 L_exit
L_omid:
    s_waitcnt vmcnt(7)
    v_mfma_f32_16x16x32_bf16 v[20:23], v[96:99], v[64:67], 0
    v_mfma_f32_16x16x32_bf16 v[24:27], v[96:99], v[68:71], 0
    v_max3_u32 v48, v96, v97, v98
    v_max_u32 v48, v48, v99
    s_waitcnt vmcnt(6)
    v_mfma_f32_16x16x32_bf16 v[20:23], v[100:103], v[72:75], v[20:23]
    v_mfma_f32_16x16x32_bf16 v[24:27], v[100:103], v[76:79], v[24:27]
    v_max3_u32 v48, v48, v100, v101
    v_max3_u32 v48, v48, v102, v103
    s_waitcnt vmcnt(5)
    v_mfma_f32_16x16x32_bf16 v[20:23], v[104:107], v[80:83], v[20:23]
    v_mfma_f32_16x16x32_bf16 v[24:27], v[104:107], v[84:87], v[24:27]
    v_max3_u32 v48, v48, v104, v105
    v_max3_u32 v48, v48, v106, v107
    s_waitcnt vmcnt(4)
    v_mfma_f32_16x16x32_bf16 v[20:23], v[108:111], v[88:91], v[20:23]
    v_mfma_f32_16x16x32_bf16 v[24:27], v[108:111], v[92:95], v[24:27]
    v_max3_u32 v48, v48, v108, v109
    v_max3_u32 v48, v48, v110, v111
    s_waitcnt vmcnt(3)
    v_mfma_f32_16x16x32_bf16 v[28:31], v[112:115], v[64:67], 0
    v_mfma_f32_16x16x32_bf16 v[32:35], v[112:115], v[68:71], 0
    v_max3_u32 v49, v112, v113, v114
    v_max_u32 v49, v49, v115
    s_waitcnt vmcnt(2)
    v_mfma_f32_16x16x32_bf16 v[28:31], v[116:119], v[72:75], v[28:31]
    v_mfma_f32_16x16x32_bf16 v[32:35], v[116:119], v[76:79], v[32:35]
    v_max3_u32 v49, v49, v116, v117
    v_max3_u32 v49, v49, v118, v119
    s_waitcnt vmcnt(1)
    v_mfma_f32_16x16x32_bf16 v[28:31], v[120:123], v[80:83], v[28:31]
    v_mfma_f32_16x16x32_bf16 v[32:35], v[120:123], v[84:87], v[32:35]
    v_max3_u32 v49, v49, v120, v121
    v_max3_u32 v49, v49, v122, v123
    s_waitcnt vmcnt(0)
    v_mfma_f32_16x16x32_bf16 v[28:31], v[124:127], v[88:91], v[28:31]
    v_mfma_f32_16x16x32_bf16 v[32:35], v[124:127], v[92:95], v[32:35]
    v_max3_u32 v49, v49, v124, v125
    v_max3_u32 v49, v49, v126, v127
    v_cmp_eq_u32 vcc, -1, v48
    v_cmp_eq_u32 s[26:27], -1, v49
    s_cbranch_vccz L_o0ok
    s_cmp_eq_u64 s[26:27], 0
    s_cbranch_scc0 L_oboth
L_oonly0:
    buffer_load_dwordx4 v[96:99], v15, s[48:51], s10 offen offset:0 sc1
    buffer_load_dwordx4 v[100:103], v15, s[48:51], s10 offen offset:1024 sc1
    buffer_load_dwordx4 v[104:107], v15, s[48:51], s10 offen offset:2048 sc1
    buffer_load_dwordx4 v[108:111], v15, s[48:51], s10 offen offset:3072 sc1
    s_add_u32 s14, s14, 1
    s_cmp_gt_u32 s14, 262144
    s_cbranch_scc1 L_exit
    s_waitcnt vmcnt(3)
    v_mfma_f32_16x16x32_bf16 v[20:23], v[96:99], v[64:67], 0
    v_mfma_f32_16x16x32_bf16 v[24:27], v[96:99], v[68:71], 0
    v_max3_u32 v48, v96, v97, v98
    v_max_u32 v48, v48, v99
    s_waitcnt vmcnt(2)
    v_mfma_f32_16x16x32_bf16 v[20:23], v[100:103], v[72:75], v[20:23]
    v_mfma_f32_16x16x32_bf16 v[24:27], v[100:103], v[76:79], v[24:27]
    v_max3_u32 v48, v48, v100, v101
    v_max3_u32 v48, v48, v102, v103
    s_waitcnt vmcnt(1)
    v_mfma_f32_16x16x32_bf16 v[20:23], v[104:107], v[80:83], v[20:23]
    v_mfma_f32_16x16x32_bf16 v[24:27], v[104:107], v[84:87], v[24:27]
    v_max3_u32 v48, v48, v104, v105
    v_max3_u32 v48, v48, v106, v107
    s_waitcnt vmcnt(0)
    v_mfma_f32_16x16x32_bf16 v[20:23], v[108:111], v[88:91], v[20:23]
    v_mfma_f32_16x16x32_bf16 v[24:27], v[108:111], v[92:95], v[24:27]
    v_max3_u32 v48, v48, v108, v109
    v_max3_u32 v48, v48, v110, v111
    v_cmp_eq_u32 vcc, -1, v48
    s_cbranch_vccnz L_oonly0
    s_branch L_odone
L_o0ok:
    s_cmp_eq_u64 s[26:27], 0
    s_cbranch_scc1 L_odone
L_oonly1:
    buffer_load_dwordx4 v[112:115], v15, s[48:51], s11 offen offset:0 sc1
    buffer_load_dwordx4 v[116:119], v15, s[48:51], s11 offen offset:1024 sc1
    buffer_load_dwordx4 v[120:123], v15, s[48:51], s11 offen offset:2048 sc1
    buffer_load_dwordx4 v[124:127], v15, s[48:51], s11 offen offset:3072 sc1
    s_add_u32 s14, s14, 1
    s_cmp_gt_u32 s14, 262144
    s_cbranch_scc1 L_exit
    s_waitcnt vmcnt(3)
    v_mfma_f32_16x16x32_bf16 v[28:31], v[112:115], v[64:67], 0
    v_mfma_f32_16x16x32_bf16 v[32:35], v[112:115], v[68:71], 0
    v_max3_u32 v49, v112, v113, v114
    v_max_u32 v49, v49, v115
    s_waitcnt vmcnt(2)
    v_mfma_f32_16x16x32_bf16 v[28:31], v[116:119], v[72:75], v[28:31]
    v_mfma_f32_16x16x32_bf16 v[32:35], v[116:119], v[76:79], v[32:35]
    v_max3_u32 v49, v49, v116, v117
    v_max3_u32 v49, v49, v118, v119
    s_waitcnt vmcnt(1)
    v_mfma_f32_16x16x32_bf16 v[28:31], v[120:123], v[80:83], v[28:31]
    v_mfma_f32_16x16x32_bf16 v[32:35], v[120:123], v[84:87], v[32:35]
    v_max3_u32 v49, v49, v120, v121
    v_max3_u32 v49, v49, v122, v123
    s_waitcnt vmcnt(0)
    v_mfma_f32_16x16x32_bf16 v[28:31], v[124:127], v[88:91], v[28:31]
    v_mfma_f32_16x16x32_bf16 v[32:35], v[124:127], v[92:95], v[32:35]
    v_max3_u32 v49, v49, v124, v125
    v_max3_u32 v49, v49, v126, v127
    v_cmp_eq_u32 vcc, -1, v49
    s_cbranch_vccnz L_oonly1
L_odone:
    s_nop 3
    v_pk_mul_f32 v[20:21], v[20:21], v[40:41]
    v_pk_mul_f32 v[24:25], v[24:25], v[40:41]
    v_pk_mul_f32 v[28:29], v[28:29], v[44:45]
    v_pk_mul_f32 v[32:33], v[32:33], v[44:45]
    v_pk_fma_f32 v[20:21], v[22:23], v[42:43], v[20:21]
    v_pk_fma_f32 v[24:25], v[26:27], v[42:43], v[24:25]
    v_pk_fma_f32 v[28:29], v[30:31], v[46:47], v[28:29]
    v_pk_fma_f32 v[32:33], v[34:35], v[46:47], v[32:33]
    v_add_f32 v20, v20, v21
    v_add_f32 v24, v24, v25
    v_add_f32 v28, v28, v29
    v_add_f32 v32, v32, v33
    s_nop 0
    v_permlane32_swap_b32 v20, v28
    v_permlane32_swap_b32 v24, v32
    v_add_f32 v20, v20, v28
    v_add_f32 v24, v24, v32
    s_nop 1
    v_permlane16_swap_b32 v20, v24
    v_add_f32 v20, v20, v38
    v_add_f32 v20, v20, v24
    ds_write_b32 v36, v20
    s_mov_b64 exec, 1
    ds_add_rtn_u32 v1, v7, v5 offset:12
    s_mov_b64 exec, -1
    ds_read_b128 v[128:131], v37 offset:0
    ds_read_b128 v[132:135], v37 offset:256
    ds_read_b128 v[136:139], v37 offset:512
    ds_read_b128 v[140:143], v37 offset:768
    s_waitcnt lgkmcnt(4)
    v_readfirstlane_b32 s10, v1
    s_cmp_eq_u32 s10, 3
    s_cbranch_scc0 L_exitW
    s_waitcnt lgkmcnt(2)
    v_pk_add_f32 v[128:129], v[128:129], v[132:133]
    v_pk_add_f32 v[130:131], v[130:131], v[134:135]
    s_waitcnt lgkmcnt(0)
    v_pk_add_f32 v[136:137], v[136:137], v[140:141]
    v_pk_add_f32 v[138:139], v[138:139], v[142:143]
    v_pk_add_f32 v[128:129], v[128:129], v[136:137]
    v_pk_add_f32 v[130:131], v[130:131], v[138:139]
    v_cvt_pk_bf16_f32 v20, v128, v129
    v_cvt_pk_bf16_f32 v21, v130, v131
    v_min_u32 v20, -2, v20
    v_min_u32 v21, -2, v21
    buffer_store_dwordx2 v[20:21], v9, s[48:51], s13 offen sc1
    buffer_store_dwordx2 v[20:21], v9, s[48:51], s28 offen sc1
L_exitW:
    s_endpgm
.p2align 12
L_ffn:
    v_and_b32 v1, 7, v0
    v_lshlrev_b32 v1, 5, v1
    v_bfe_u32 v4, v0, 3, 2
    v_lshl_add_u32 v1, v4, 2, v1
    v_add_u32 v1, s9, v1
    v_lshlrev_b32 v4, 4, v1
    s_mov_b32 s14, 0
    s_mov_b32 s10, 0x4000
L_tag25:
    buffer_load_dwordx2 v[24:25], v4, s[48:51], s10 offen sc1
    s_add_u32 s14, s14, 1
    s_cmp_gt_u32 s14, 262144
    s_cbranch_scc1 L_exit
    s_waitcnt vmcnt(0)
    v_xor_b32 v24, v24, v2
    v_xor_b32 v25, v25, v3
    v_or_b32 v24, v24, v25
    v_cmp_ne_u32 vcc, 0, v24
    s_and_b64 exec, exec, vcc
    s_cbranch_scc1 L_tag25
    s_mov_b64 exec, -1
    v_lshlrev_b32 v48, 6, v13
    v_lshl_add_u32 v48, v12, 4, v48
    s_cmp_ge_u32 s9, 2
    s_cselect_b32 s10, 0x10000000, 0
    v_add_u32 v49, s10, v48
    v_lshlrev_b32 v1, 3, v0
    v_add_u32 v51, 0x22400, v1
    s_lshl_b32 s10, s9, 9
    v_add_u32 v50, s10, v51
    s_lshl_b32 s10, s9, 7
    s_add_u32 s10, s10, 0x23800
    v_lshlrev_b32 v1, 1, v0
    v_add_u32 v54, s10, v1
    v_lshrrev_b32 v1, 3, v13
    v_lshlrev_b32 v1, 6, v1
    v_lshl_add_u32 v1, v12, 4, v1
    v_add_u32 v1, s10, v1
    v_and_b32 v4, 7, v0
    v_mov_b32 v55, 0x26770
    v_cmp_eq_u32 vcc, 0, v4
    s_nop 1
    v_cndmask_b32 v56, v55, v1, vcc
    v_cmp_eq_u32 vcc, 1, v4
    s_nop 1
    v_cndmask_b32 v57, v55, v1, vcc
    v_cmp_eq_u32 vcc, 2, v4
    s_nop 1
    v_cndmask_b32 v58, v55, v1, vcc
    v_cmp_eq_u32 vcc, 3, v4
    s_nop 1
    v_cndmask_b32 v59, v55, v1, vcc
    v_cmp_eq_u32 vcc, 4, v4
    s_nop 1
    v_cndmask_b32 v60, v55, v1, vcc
    v_cmp_eq_u32 vcc, 5, v4
    s_nop 1
    v_cndmask_b32 v61, v55, v1, vcc
    v_cmp_eq_u32 vcc, 6, v4
    s_nop 1
    v_cndmask_b32 v62, v55, v1, vcc
    v_cmp_eq_u32 vcc, 7, v4
    s_nop 1
    v_cndmask_b32 v63, v55, v1, vcc
    v_mov_b32 v40, 0x3f803f80
    v_mov_b32 v41, 0x3f803f80
    v_mov_b32 v42, 0x3f803f80
    v_mov_b32 v43, 0x3f803f80
    s_lshl_b32 s16, s9, 10
    s_add_u32 s16, s16, 0xc0000
    s_lshl_b32 s10, s4, 14
    s_add_u32 s16, s16, s10
    s_add_u32 s17, s16, 4096
    s_add_u32 s18, s16, 8192
    s_add_u32 s19, s16, 12288
    s_mul_i32 s11, s83, 3584
    s_lshl_b32 s12, s9, 10
    s_add_u32 s11, s11, s12
    s_add_u32 s21, s11, 0x80000
    s_cmp_eq_u32 s9, 3
    s_cselect_b32 s20, 0, -1
    s_mov_b32 s24, 0xffff0000
    s_mov_b32 s25, 0xffff0000
    v_mul_u32_u24 v9, 3584, v8
    v_lshl_add_u32 v9, v11, 4, v9
    v_xor_b32 v1, v12, v13
    v_mul_u32_u24 v17, 896, v12
    v_lshl_add_u32 v17, v1, 4, v17
    s_cmp_eq_u32 s9, 3
    s_cselect_b32 s10, 8, 16
    v_cmp_gt_u32 vcc, s10, v13
    v_mov_b32 v1, 0x10000000
    s_nop 0
    v_cndmask_b32 v17, v1, v17, vcc
    v_lshlrev_b32 v1, 8, v10
    v_lshl_add_u32 v1, v11, 6, v1
    v_bfe_u32 v4, v0, 2, 2
    v_lshl_add_u32 v1, v4, 4, v1
    v_add_u32 v64, s80, v1
    v_xor_b32 v65, 16, v64
    v_xor_b32 v66, 32, v64
    v_xor_b32 v67, 48, v64
    s_mul_i32 s28, s9, 114688
    s_lshl_b32 s11, s83, 6
    s_add_u32 s28, s28, s11
    s_add_u32 s29, s28, 57344
    s_mul_i32 s30, s83, 28672
    s_lshl_b32 s11, s9, 8
    s_add_u32 s30, s30, s11
    s_sub_u32 s11, s5, 14
    s_lshl3_add_u32 s11, s4, s11
    s_lshl2_add_u32 s11, s11, s9
    s_lshl2_add_u32 s33, s11, 0x6000
    s_mov_b32 s12, 0
    s_mov_b32 s14, 0
L_spin26:
    ds_read_b32 v1, v6 offset:16
    s_add_u32 s14, s14, 1
    s_waitcnt lgkmcnt(0)
    v_readfirstlane_b32 s10, v1
    s_cmp_ge_u32 s10, 40
    s_cbranch_scc1 L_got27
    s_cmp_gt_u32 s14, 2097152
    s_cbranch_scc1 L_exit
    s_sleep 1
    s_branch L_spin26
L_got27:
    s_lshl2_add_u32 s10, s8, s9
    s_mul_i32 s10, s10, 3584
    v_lshlrev_b32 v1, 7, v0
    s_mov_b64 exec, 0xfffffff
    buffer_load_dword v220, v1, s[60:63], s10 offen
    s_mov_b64 exec, -1
    s_mov_b32 s14, 0
L_spin28:
    ds_read_b128 v[24:27], v7 offset:16
    s_add_u32 s14, s14, 1
    s_waitcnt lgkmcnt(0)
    v_min3_u32 v1, v24, v25, v26
    v_min_u32 v1, v1, v27
    s_nop 0
    v_readfirstlane_b32 s10, v1
    s_cmp_ge_u32 s10, 40
    s_cbranch_scc1 L_got29
    s_cmp_gt_u32 s14, 2097152
    s_cbranch_scc1 L_exit
    s_sleep 1
    s_branch L_spin28
L_got29:
    buffer_load_dwordx4 v9, s[64:67], s28 offen lds
    s_add_u32 m0, m0, 1024
    s_nop 0
    buffer_load_dwordx4 v9, s[64:67], s29 offen lds
    s_add_u32 m0, m0, 1024
    s_mov_b32 s14, 0
L_spin30:
    ds_read_b32 v1, v7 offset:8
    s_add_u32 s14, s14, 1
    s_waitcnt lgkmcnt(0)
    v_readfirstlane_b32 s10, v1
    s_cmp_ge_u32 s10, 1
    s_cbranch_scc1 L_got31
    s_cmp_gt_u32 s14, 2097152
    s_cbranch_scc1 L_exit
    s_sleep 1
    s_branch L_spin30
L_got31:
    buffer_load_dwordx4 v9, s[68:71], s28 offen lds
    s_add_u32 m0, m0, 1024
    s_nop 0
    buffer_load_dwordx4 v9, s[68:71], s29 offen lds
    s_add_u32 m0, m0, 1024
    s_add_u32 s28, s28, 458752
    s_add_u32 s29, s29, 458752
    buffer_load_dwordx4 v9, s[64:67], s28 offen lds
    s_add_u32 m0, m0, 1024
    s_nop 0
    buffer_load_dwordx4 v9, s[64:67], s29 offen lds
    s_add_u32 m0, m0, 1024
    s_nop 0
    buffer_load_dwordx4 v9, s[68:71], s28 offen lds
    s_add_u32 m0, m0, 1024
    s_nop 0
    buffer_load_dwordx4 v9, s[68:71], s29 offen lds
    s_add_u32 m0, m0, 1024
    s_add_u32 s28, s28, 458752
    s_add_u32 s29, s29, 458752
    buffer_load_dwordx4 v9, s[64:67], s28 offen lds
    s_add_u32 m0, m0, 1024
    s_nop 0
    buffer_load_dwordx4 v9, s[64:67], s29 offen lds
    s_add_u32 m0, m0, 1024
    s_nop 0
    buffer_load_dwordx4 v9, s[68:71], s28 offen lds
    s_add_u32 m0, m0, 1024
    s_nop 0
    buffer_load_dwordx4 v9, s[68:71], s29 offen lds
    s_add_u32 m0, m0, 1024
    s_add_u32 s28, s28, 458752
    s_add_u32 s29, s29, 458752
    s_waitcnt vmcnt(8)
    ds_read_b64_tr_b16 v[80:81], v16 offset:0
    ds_read_b64_tr_b16 v[82:83], v16 offset:256
    ds_read_b64_tr_b16 v[84:85], v16 offset:32
    ds_read_b64_tr_b16 v[86:87], v16 offset:288
    ds_read_b64_tr_b16 v[88:89], v16 offset:2048
    ds_read_b64_tr_b16 v[90:91], v16 offset:2304
    ds_read_b64_tr_b16 v[92:93], v16 offset:2080
    ds_read_b64_tr_b16 v[94:95], v16 offset:2336
    buffer_load_dwordx4 v9, s[64:67], s28 offen lds
    s_add_u32 m0, m0, 1024
    s_nop 0
    buffer_load_dwordx4 v9, s[64:67], s29 offen lds
    s_add_u32 m0, m0, 1024
    s_nop 0
    buffer_load_dwordx4 v9, s[68:71], s28 offen lds
    s_add_u32 m0, m0, 1024
    s_nop 0
    buffer_load_dwordx4 v9, s[68:71], s29 offen lds
    s_add_u32 m0, m0, 1024
    s_waitcnt vmcnt(8)
    s_waitcnt lgkmcnt(0)
    ds_read_b64_tr_b16 v[96:97], v16 offset:4096
    ds_read_b64_tr_b16 v[98:99], v16 offset:4352
    ds_read_b64_tr_b16 v[100:101], v16 offset:4128
    ds_read_b64_tr_b16 v[102:103], v16 offset:4384
    ds_read_b64_tr_b16 v[104:105], v16 offset:6144
    ds_read_b64_tr_b16 v[106:107], v16 offset:6400
    ds_read_b64_tr_b16 v[108:109], v16 offset:6176
    ds_read_b64_tr_b16 v[110:111], v16 offset:6432
    v_mfma_f32_16x16x32_bf16 v[20:23], v[40:43], v[80:83], 0
    v_mfma_f32_16x16x32_bf16 v[24:27], v[40:43], v[84:87], 0
    v_mfma_f32_16x16x32_bf16 v[28:31], v[40:43], v[88:91], 0
    v_mfma_f32_16x16x32_bf16 v[32:35], v[40:43], v[92:95], 0
    buffer_load_dwordx4 v17, s[72:75], s30 offen lds
    s_add_u32 m0, m0, 1024
    s_add_u32 s30, s30, 3584
    buffer_load_dwordx4 v17, s[72:75], s30 offen lds
    s_add_u32 m0, m0, 1024
    s_add_u32 s30, s30, 3584
    buffer_load_dwordx4 v17, s[72:75], s30 offen lds
    s_add_u32 m0, m0, 1024
    s_add_u32 s30, s30, 3584
    buffer_load_dwordx4 v17, s[72:75], s30 offen lds
    s_add_u32 m0, m0, 1024
    s_add_u32 s30, s30, 3584
    s_waitcnt vmcnt(8)
    s_waitcnt lgkmcnt(0)
    ds_read_b64_tr_b16 v[112:113], v16 offset:8192
    ds_read_b64_tr_b16 v[114:115], v16 offset:8448
    ds_read_b64_tr_b16 v[116:117], v16 offset:8224
    ds_read_b64_tr_b16 v[118:119], v16 offset:8480
    ds_read_b64_tr_b16 v[120:121], v16 offset:10240
    ds_read_b64_tr_b16 v[122:123], v16 offset:10496
    ds_read_b64_tr_b16 v[124:125], v16 offset:10272
    ds_read_b64_tr_b16 v[126:127], v16 offset:10528
    v_mfma_f32_16x16x32_bf16 v[20:23], v[40:43], v[96:99], v[20:23]
    v_mfma_f32_16x16x32_bf16 v[24:27], v[40:43], v[100:103], v[24:27]
    v_mfma_f32_16x16x32_bf16 v[28:31], v[40:43], v[104:107], v[28:31]
    v_mfma_f32_16x16x32_bf16 v[32:35], v[40:43], v[108:111], v[32:35]
    buffer_load_dwordx4 v17, s[72:75], s30 offen lds
    s_add_u32 m0, m0, 1024
    s_add_u32 s30, s30, 3584
    buffer_load_dwordx4 v17, s[72:75], s30 offen lds
    s_add_u32 m0, m0, 1024
    s_add_u32 s30, s30, 3584
    buffer_load_dwordx4 v17, s[72:75], s30 offen lds
    s_add_u32 m0, m0, 1024
    s_add_u32 s30, s30, 3584
    buffer_load_dwordx4 v17, s[72:75], s30 offen lds
    s_add_u32 m0, m0, 1024
    s_waitcnt vmcnt(8)
    buffer_load_dwordx4 v[176:179], v48, s[48:51], s16 offen sc1
    buffer_load_dwordx4 v[180:183], v48, s[48:51], s17 offen sc1
    buffer_load_dwordx4 v[184:187], v48, s[48:51], s18 offen sc1
    buffer_load_dwordx4 v[188:191], v49, s[48:51], s19 offen sc1
    s_waitcnt lgkmcnt(0)
    ds_read_b64_tr_b16 v[128:129], v16 offset:12288
    ds_read_b64_tr_b16 v[130:131], v16 offset:12544
    ds_read_b64_tr_b16 v[132:133], v16 offset:12320
    ds_read_b64_tr_b16 v[134:135], v16 offset:12576
    ds_read_b64_tr_b16 v[136:137], v16 offset:14336
    ds_read_b64_tr_b16 v[138:139], v16 offset:14592
    ds_read_b64_tr_b16 v[140:141], v16 offset:14368
    ds_read_b64_tr_b16 v[142:143], v16 offset:14624
    v_mfma_f32_16x16x32_bf16 v[20:23], v[40:43], v[112:115], v[20:23]
    v_mfma_f32_16x16x32_bf16 v[24:27], v[40:43], v[116:119], v[24:27]
    v_mfma_f32_16x16x32_bf16 v[28:31], v[40:43], v[120:123], v[28:31]
    v_mfma_f32_16x16x32_bf16 v[32:35], v[40:43], v[124:127], v[32:35]
    s_waitcnt lgkmcnt(0)
    v_mfma_f32_16x16x32_bf16 v[20:23], v[40:43], v[128:131], v[20:23]
    v_mfma_f32_16x16x32_bf16 v[24:27], v[40:43], v[132:135], v[24:27]
    v_mfma_f32_16x16x32_bf16 v[28:31], v[40:43], v[136:139], v[28:31]
    v_mfma_f32_16x16x32_bf16 v[32:35], v[40:43], v[140:143], v[32:35]
    s_nop 5
    v_cndmask_b32 v46, v20, v24, s[24:25]
    s_nop 0
    v_cndmask_b32 v47, v28, v32, s[24:25]
    ds_write_b64 v50, v[46:47] offset:2048
    s_waitcnt lgkmcnt(0)
    s_barrier
    ds_read2st64_b64 v[20:23], v51 offset0:4 offset1:5
    ds_read2st64_b64 v[24:27], v51 offset0:6 offset1:7
    s_waitcnt vmcnt(4) lgkmcnt(0)
    ds_read_b64_tr_b16 v[144:145], v64 offset:16384
    ds_read_b64_tr_b16 v[146:147], v64 offset:17408
    ds_read_b64_tr_b16 v[148:149], v64 offset:16392
    ds_read_b64_tr_b16 v[150:151], v64 offset:17416
    ds_read_b64_tr_b16 v[152:153], v65 offset:16384
    ds_read_b64_tr_b16 v[154:155], v65 offset:17408
    ds_read_b64_tr_b16 v[156:157], v65 offset:16392
    ds_read_b64_tr_b16 v[158:159], v65 offset:17416
    ds_read_b64_tr_b16 v[160:161], v66 offset:16384
    ds_read_b64_tr_b16 v[162:163], v66 offset:17408
    ds_read_b64_tr_b16 v[164:165], v66 offset:16392
    ds_read_b64_tr_b16 v[166:167], v66 offset:17416
    s_waitcnt lgkmcnt(4)
    ds_read_b64_tr_b16 v[168:169], v67 offset:16384
    ds_read_b64_tr_b16 v[170:171], v67 offset:17408
    ds_read_b64_tr_b16 v[172:173], v67 offset:16392
    ds_read_b64_tr_b16 v[174:175], v67 offset:17416
    v_pk_add_f32 v[20:21], v[20:21], v[22:23]
    v_pk_add_f32 v[24:25], v[24:25], v[26:27]
    v_pk_add_f32 v[46:47], v[20:21], v[24:25]
    v_mul_f32 v46, 0xbb124925, v46
    v_mul_f32 v47, 0xbb124925, v47
    s_mov_b32 s14, 0
    s_branch L_pmid
L_ppoll:
    buffer_load_dwordx4 v[176:179], v48, s[48:51], s16 offen sc1
    buffer_load_dwordx4 v[180:183], v48, s[48:51], s17 offen sc1
    buffer_load_dwordx4 v[184:187], v48, s[48:51], s18 offen sc1
    buffer_load_dwordx4 v[188:191], v49, s[48:51], s19 offen sc1
    s_add_u32 s14, s14, 1
    s_cmp_gt_u32 s14, 262144
    s_cbranch_scc1 L_exit
L_pmid:
    s_waitcnt vmcnt(3)
    v_mfma_f32_16x16x32_bf16 v[196:199], v[176:179], v[40:43], 0
    v_max3_u32 v1, v176, v177, v178
    v_max_u32 v1, v1, v179
    s_waitcnt vmcnt(2)
    v_mfma_f32_16x16x32_bf16 v[196:199], v[180:183], v[40:43], v[196:199]
    v_max3_u32 v1, v1, v180, v181
    v_max3_u32 v1, v1, v182, v183
    s_waitcnt vmcnt(1)
    v_mfma_f32_16x16x32_bf16 v[196:199], v[184:187], v[40:43], v[196:199]
    v_max3_u32 v1, v1, v184, v185
    v_max3_u32 v1, v1, v186, v187
    s_waitcnt vmcnt(0)
    v_mfma_f32_16x16x32_bf16 v[196:199], v[188:191], v[40:43], v[196:199]
    v_max3_u32 v1, v1, v188, v189
    v_max3_u32 v1, v1, v190, v191
    v_mfma_f32_16x16x32_bf16 v[20:23], v[176:179], v[80:83], 0
    v_mfma_f32_16x16x32_bf16 v[24:27], v[176:179], v[84:87], 0
    v_cmp_eq_u32 vcc, -1, v1
    s_and_b64 exec, exec, vcc
    s_cbranch_scc1 L_ppoll
    s_mov_b64 exec, -1
    v_mfma_f32_16x16x32_bf16 v[28:31], v[176:179], v[88:91], 0
    v_mfma_f32_16x16x32_bf16 v[32:35], v[176:179], v[92:95], 0
    v_mfma_f32_16x16x32_bf16 v[20:23], v[180:183], v[96:99], v[20:23]
    v_mfma_f32_16x16x32_bf16 v[24:27], v[180:183], v[100:103], v[24:27]
    v_mfma_f32_16x16x32_bf16 v[28:31], v[180:183], v[104:107], v[28:31]
    v_mfma_f32_16x16x32_bf16 v[32:35], v[180:183], v[108:111], v[32:35]
    v_mfma_f32_16x16x32_bf16 v[20:23], v[184:187], v[112:115], v[20:23]
    v_pk_add_f32 v[196:197], v[196:197], v[198:199]
    v_mfma_f32_16x16x32_bf16 v[24:27], v[184:187], v[116:119], v[24:27]
    v_mfma_f32_16x16x32_bf16 v[28:31], v[184:187], v[120:123], v[28:31]
    v_permlane32_swap_b32 v196, v197
    v_mfma_f32_16x16x32_bf16 v[32:35], v[184:187], v[124:127], v[32:35]
    v_add_f32 v196, v196, v197
    v_mfma_f32_16x16x32_bf16 v[20:23], v[188:191], v[128:131], v[20:23]
    v_mov_b32 v197, v196
    v_mfma_f32_16x16x32_bf16 v[24:27], v[188:191], v[132:135], v[24:27]
    v_mfma_f32_16x16x32_bf16 v[28:31], v[188:191], v[136:139], v[28:31]
    v_permlane16_swap_b32 v196, v197
    v_mfma_f32_16x16x32_bf16 v[32:35], v[188:191], v[140:143], v[32:35]
    v_add_f32 v196, v196, v197
    v_mul_f32 v44, v196, v46
    v_mul_f32 v45, v196, v47
    v_pk_add_f32 v[20:21], v[20:21], v[22:23]
    s_nop 0
    v_pk_add_f32 v[24:25], v[24:25], v[26:27]
    v_pk_add_f32 v[28:29], v[28:29], v[30:31]
    s_nop 0
    v_pk_add_f32 v[32:33], v[32:33], v[34:35]
    v_permlane32_swap_b32 v20, v21
    v_permlane32_swap_b32 v24, v25
    v_permlane32_swap_b32 v28, v29
    v_permlane32_swap_b32 v32, v33
    v_add_f32 v20, v20, v21
    v_add_f32 v24, v24, v25
    v_add_f32 v28, v28, v29
    v_add_f32 v32, v32, v33
    v_permlane16_swap_b32 v20, v24
    s_nop 0
    v_permlane16_swap_b32 v28, v32
    v_add_f32 v44, v44, v20
    v_add_f32 v45, v45, v28
    v_add_f32 v44, v44, v24
    v_add_f32 v45, v45, v32
    ds_write_b64 v50, v[44:45]
    s_waitcnt lgkmcnt(0)
    s_barrier
    ds_read2st64_b64 v[20:23], v51 offset0:0 offset1:1
    ds_read2st64_b64 v[24:27], v51 offset0:2 offset1:3
    s_waitcnt lgkmcnt(1)
    v_pk_add_f32 v[20:21], v[20:21], v[22:23]
    s_waitcnt lgkmcnt(0)
    v_pk_add_f32 v[24:25], v[24:25], v[26:27]
    v_pk_add_f32 v[20:21], v[20:21], v[24:25]
    v_mul_f32 v20, v20, v21
    v_cvt_pk_bf16_f32 v20, v20, v20
    ds_write_b16 v54, v20
    ds_read_b128 v[96:99], v56
    ds_read_b128 v[100:103], v57
    ds_read_b128 v[104:107], v58
    ds_read_b128 v[108:111], v59
    ds_read_b128 v[112:115], v60
    ds_read_b128 v[116:119], v61
    ds_read_b128 v[120:123], v62
    ds_read_b128 v[124:127], v63
    s_waitcnt lgkmcnt(7)
    v_mfma_f32_16x16x32_bf16 v[24:27], v[144:147], v[96:99], 0
    s_waitcnt lgkmcnt(6)
    v_mfma_f32_16x16x32_bf16 v[24:27], v[148:151], v[100:103], v[24:27]
    s_waitcnt lgkmcnt(5)
    v_mfma_f32_16x16x32_bf16 v[24:27], v[152:155], v[104:107], v[24:27]
    s_waitcnt lgkmcnt(4)
    v_mfma_f32_16x16x32_bf16 v[24:27], v[156:159], v[108:111], v[24:27]
    s_waitcnt lgkmcnt(3)
    v_mfma_f32_16x16x32_bf16 v[24:27], v[160:163], v[112:115], v[24:27]
    s_waitcnt lgkmcnt(2)
    v_mfma_f32_16x16x32_bf16 v[24:27], v[164:167], v[116:119], v[24:27]
    s_waitcnt lgkmcnt(1)
    v_mfma_f32_16x16x32_bf16 v[24:27], v[168:171], v[120:123], v[24:27]
    s_waitcnt lgkmcnt(0)
    v_mfma_f32_16x16x32_bf16 v[24:27], v[172:175], v[124:127], v[24:27]
    s_mov_b32 exec_hi, s20
    s_nop 6
    v_min_u32 v24, -2, v24
    v_min_u32 v25, -2, v25
    v_min_u32 v26, -2, v26
    v_min_u32 v27, -2, v27
    buffer_store_dwordx4 v[24:27], v15, s[48:51], s21 offen sc1
    s_mov_b64 exec, 1
    s_cmp_eq_u32 s15, 2
    s_cbranch_scc0 L_far32
    buffer_store_dword v2, v14, s[48:51], s33 offen
L_st33:
    s_endpgm
L_far32:
    buffer_store_dword v2, v14, s[48:51], s33 offen sc1
    s_branch L_st33
.p2align 12
L_final:
    s_lshl2_add_u32 s10, s4, s5
    s_sub_u32 s80, s10, 21
    s_mov_b32 s76, s34
    s_mov_b32 s77, s35
    s_mov_b32 s78, 0x700
    s_mov_b32 s79, 0x20000
    v_mov_b32 v9, 0
    v_mov_b32 v10, 0
    v_mov_b32 v11, 0
    v_mov_b32 v17, 0
    s_mov_b32 s30, 0
    s_cmp_lt_u32 s5, 25
    s_cbranch_scc0 L_fin1
    s_cmp_lt_u32 s4, 7
    s_cbranch_scc0 L_fin1
    s_cmp_lt_u32 s9, 2
    s_cbranch_scc0 L_fin1
    s_mov_b32 s30, 1
    s_lshl_b32 s16, s80, 7
    s_add_u32 s16, s16, 0x80000
    s_and_b32 s11, s80, 1
    s_lshr_b32 s12, s80, 1
    v_lshrrev_b32 v8, 3, v0
    v_and_b32 v9, 7, v0
    v_add_u32 v1, 14, v8
    v_mov_b32 v4, s12
    v_cmp_eq_u32 vcc, 7, v8
    s_nop 1
    v_cndmask_b32 v1, v1, v4, vcc
    v_lshl_add_u32 v1, v9, 5, v1
    v_lshlrev_b32 v4, 4, v1
    v_lshlrev_b32 v10, 3, v9
    v_lshl_add_u32 v11, v8, 7, v10
    v_lshl_add_u32 v10, v12, 1, v10
    v_mul_u32_u24 v8, 3584, v8
    v_lshl_add_u32 v9, v9, 4, v8
    s_mul_i32 s23, s11, 896
    s_lshl_b32 s13, s12, 6
    s_add_u32 s23, s23, s13
    buffer_load_ushort v16, v10, s[76:79], s23 offen
    s_lshl_b32 s24, s12, 10
    s_lshl_b32 s13, s11, 6
    s_add_u32 s24, s24, s13
    s_add_u32 s24, s24, 0xc0000
    s_lshl_b32 s13, s4, 14
    s_add_u32 s24, s24, s13
    s_add_u32 s17, s16, 28672
    s_add_u32 s18, s16, 57344
    s_add_u32 s19, s16, 86016
    s_add_u32 s20, s16, 114688
    s_add_u32 s21, s16, 143360
    s_add_u32 s22, s16, 172032
    s_lshl_b32 s26, s11, 6
    s_add_u32 s26, s26, s13
    s_add_u32 s26, s26, 0xc0000
    s_add_u32 s27, s26, 4096
    s_add_u32 s28, s26, 8192
    s_add_u32 s29, s26, 12288
    v_lshlrev_b32 v17, 7, v13
    v_lshl_add_u32 v17, v12, 4, v17
    s_cmp_eq_u32 s9, 0
    s_cbranch_scc1 L_tagF
    v_and_b32 v1, 7, v0
    v_lshlrev_b32 v1, 5, v1
    v_lshrrev_b32 v4, 3, v0
    v_add_u32 v1, v1, v4
    v_lshlrev_b32 v4, 4, v1
    s_mov_b32 s14, 0
    s_mov_b32 s10, 0x4000
L_tag34:
    buffer_load_dwordx2 v[24:25], v4, s[48:51], s10 offen sc1
    s_add_u32 s14, s14, 1
    s_cmp_gt_u32 s14, 262144
    s_cbranch_scc1 L_exit
    s_waitcnt vmcnt(0)
    v_xor_b32 v24, v24, v2
    v_xor_b32 v25, v25, v3
    v_or_b32 v24, v24, v25
    v_cmp_ne_u32 vcc, 0, v24
    s_and_b64 exec, exec, vcc
    s_cbranch_scc1 L_tag34
    s_mov_b64 exec, -1
    v_add_u32 v4, 128, v4
L_tagF:
    s_mov_b32 s14, 0
    s_mov_b32 s10, 0x4000
L_tag35:
    buffer_load_dwordx2 v[24:25], v4, s[48:51], s10 offen sc1
    s_add_u32 s14, s14, 1
    s_cmp_gt_u32 s14, 262144
    s_cbranch_scc1 L_exit
    s_waitcnt vmcnt(0)
    v_xor_b32 v24, v24, v2
    v_xor_b32 v25, v25, v3
    v_or_b32 v24, v24, v25
    v_cmp_ne_u32 vcc, 0, v24
    s_and_b64 exec, exec, vcc
    s_cbranch_scc1 L_tag35
    s_mov_b64 exec, -1
L_fin1:
    s_sub_u32 s11, s5, 21
    s_lshl2_add_u32 s11, s11, s9
    s_mul_i32 s12, s11, 30
    s_add_u32 s12, s12, 512
    v_add_u32 v1, s12, v0
    v_min_u32 v1, 1791, v1
    v_lshrrev_b32 v4, 2, v1
    v_mul_u32_u24 v4, 3584, v4
    v_and_b32 v1, 3, v1
    v_lshl_add_u32 v4, v1, 7, v4
    s_mul_i32 s12, s11, 12
    v_add_u32 v1, s12, v0
    v_lshrrev_b32 v19, 2, v1
    v_mul_u32_u24 v19, 3584, v19
    v_and_b32 v1, 3, v1
    v_lshl_add_u32 v19, v1, 7, v19
    s_mul_i32 s12, s11, 36
    v_add_u32 v1, s12, v0
    v_min_u32 v1, 1567, v1
    v_lshlrev_b32 v18, 7, v1
    s_mul_i32 s12, s4, 448
    s_and_b32 s12, s12, -128
    s_mul_i32 s13, s4, 200704
    s_mov_b32 s14, 0
L_spin36:
    ds_read_b32 v1, v6 offset:16
    s_add_u32 s14, s14, 1
    s_waitcnt lgkmcnt(0)
    v_readfirstlane_b32 s10, v1
    s_cmp_ge_u32 s10, 40
    s_cbranch_scc1 L_got37
    s_cmp_gt_u32 s14, 2097152
    s_cbranch_scc1 L_exit
    s_sleep 1
    s_branch L_spin36
L_got37:
    s_lshl2_add_u32 s10, s8, s9
    s_mul_i32 s10, s10, 3584
    v_lshlrev_b32 v1, 7, v0
    s_mov_b64 exec, 0xfffffff
    buffer_load_dword v220, v1, s[60:63], s10 offen
    s_mov_b64 exec, -1
    s_mov_b32 s14, 0
L_spin38:
    ds_read_b32 v1, v7 offset:8
    s_add_u32 s14, s14, 1
    s_waitcnt lgkmcnt(0)
    v_readfirstlane_b32 s10, v1
    s_cmp_ge_u32 s10, 1
    s_cbranch_scc1 L_got39
    s_cmp_gt_u32 s14, 2097152
    s_cbranch_scc1 L_exit
    s_sleep 1
    s_branch L_spin38
L_got39:
    s_mov_b32 exec_hi, 0x1ff
    s_mov_b64 exec, 0x3fffffff
    buffer_load_dword v216, v4, s[64:67], s12 offen
    buffer_load_dword v217, v4, s[68:71], s12 offen
    s_mov_b64 exec, 0xfff
    buffer_load_dword v214, v19, s[64:67], s12 offen
    buffer_load_dword v215, v19, s[68:71], s12 offen
    s_mov_b64 exec, -1
    s_mov_b32 exec_hi, 0xf
    buffer_load_dword v218, v18, s[72:75], s13 offen
    s_mov_b64 exec, -1
    s_cmp_eq_u32 s30, 1
    s_cbranch_scc0 L_exit
    s_cmp_eq_u32 s9, 0
    s_cbranch_scc1 L_fin2
    v_mov_b32 v60, 0x3f803f80
    v_mov_b32 v61, 0x3f803f80
    v_mov_b32 v62, 0x3f803f80
    v_mov_b32 v63, 0x3f803f80
    s_mov_b32 s14, 0
L_spin40:
    ds_read_b32 v1, v7 offset:8
    s_add_u32 s14, s14, 1
    s_waitcnt lgkmcnt(0)
    v_readfirstlane_b32 s10, v1
    s_cmp_ge_u32 s10, 2
    s_cbranch_scc1 L_got41
    s_cmp_gt_u32 s14, 2097152
    s_cbranch_scc1 L_exit
    s_sleep 1
    s_branch L_spin40
L_got41:
    s_mov_b32 s14, 0
L_poll42:
    buffer_load_dwordx4 v[64:67], v17, s[48:51], s26 offen offset:0 sc1
    buffer_load_dwordx4 v[68:71], v17, s[48:51], s26 offen offset:2048 sc1
    buffer_load_dwordx4 v[72:75], v17, s[48:51], s27 offen offset:0 sc1
    buffer_load_dwordx4 v[76:79], v17, s[48:51], s27 offen offset:2048 sc1
    buffer_load_dwordx4 v[80:83], v17, s[48:51], s28 offen offset:0 sc1
    buffer_load_dwordx4 v[84:87], v17, s[48:51], s28 offen offset:2048 sc1
    buffer_load_dwordx4 v[88:91], v17, s[48:51], s29 offen offset:0 sc1
    s_add_u32 s14, s14, 1
    s_cmp_gt_u32 s14, 262144
    s_cbranch_scc1 L_exit
    s_waitcnt vmcnt(0)
    v_max3_u32 v1, v64, v65, v66
    v_max3_u32 v1, v1, v67, v68
    v_max3_u32 v1, v1, v69, v70
    v_max3_u32 v1, v1, v71, v72
    v_max3_u32 v1, v1, v73, v74
    v_max3_u32 v1, v1, v75, v76
    v_max3_u32 v1, v1, v77, v78
    v_max3_u32 v1, v1, v79, v80
    v_max3_u32 v1, v1, v81, v82
    v_max3_u32 v1, v1, v83, v84
    v_max3_u32 v1, v1, v85, v86
    v_max3_u32 v1, v1, v87, v88
    v_max3_u32 v1, v1, v89, v90
    v_max_u32 v1, v1, v91
    v_cmp_eq_u32 vcc, -1, v1
    s_and_b64 exec, exec, vcc
    s_cbranch_scc1 L_poll42
    s_mov_b64 exec, -1
    v_mfma_f32_16x16x32_bf16 v[92:95], v[64:67], v[64:67], 0
    v_mfma_f32_16x16x32_bf16 v[96:99], v[64:67], v[60:63], 0
    v_mfma_f32_16x16x32_bf16 v[92:95], v[68:71], v[68:71], v[92:95]
    v_mfma_f32_16x16x32_bf16 v[96:99], v[68:71], v[60:63], v[96:99]
    v_mfma_f32_16x16x32_bf16 v[92:95], v[72:75], v[72:75], v[92:95]
    v_mfma_f32_16x16x32_bf16 v[96:99], v[72:75], v[60:63], v[96:99]
    v_mfma_f32_16x16x32_bf16 v[92:95], v[76:79], v[76:79], v[92:95]
    v_mfma_f32_16x16x32_bf16 v[96:99], v[76:79], v[60:63], v[96:99]
    v_mfma_f32_16x16x32_bf16 v[92:95], v[80:83], v[80:83], v[92:95]
    v_mfma_f32_16x16x32_bf16 v[96:99], v[80:83], v[60:63], v[96:99]
    v_mfma_f32_16x16x32_bf16 v[92:95], v[84:87], v[84:87], v[92:95]
    v_mfma_f32_16x16x32_bf16 v[96:99], v[84:87], v[60:63], v[96:99]
    v_mfma_f32_16x16x32_bf16 v[92:95], v[88:91], v[88:91], v[92:95]
    v_mfma_f32_16x16x32_bf16 v[96:99], v[88:91], v[60:63], v[96:99]
    s_mov_b32 vcc_lo, 0x00ff00ff
    s_mov_b32 vcc_hi, 0xff00ff00
    s_nop 4
    v_pk_add_f32 v[92:93], v[92:93], v[94:95]
    v_pk_add_f32 v[96:97], v[96:97], v[98:99]
    v_add_f32 v92, v92, v93
    v_add_f32 v96, v96, v97
    v_cndmask_b32 v92, 0, v92, vcc
    s_nop 1
    v_add_f32_dpp v92, v92, v92 row_ror:8 row_mask:0xf bank_mask:0xf
    s_nop 1
    v_add_f32_dpp v92, v92, v92 row_ror:4 row_mask:0xf bank_mask:0xf
    s_nop 1
    v_add_f32_dpp v92, v92, v92 row_ror:2 row_mask:0xf bank_mask:0xf
    s_nop 1
    v_add_f32_dpp v92, v92, v92 row_ror:1 row_mask:0xf bank_mask:0xf
    v_mov_b32 v93, v92
    v_mov_b32 v97, v96
    s_nop 0
    v_permlane16_swap_b32 v92, v93
    v_permlane16_swap_b32 v96, v97
    v_add_f32 v92, v92, v93
    v_add_f32 v96, v96, v97
    v_mov_b32 v93, v92
    v_mov_b32 v97, v96
    s_nop 0
    v_permlane32_swap_b32 v92, v93
    v_permlane32_swap_b32 v96, v97
    v_add_f32 v92, v92, v93
    v_add_f32 v96, v96, v97
    v_mul_f32 v96, 0x3b124925, v96
    v_mul_f32 v92, 0x3b124925, v92
    v_fma_f32 v92, -v96, v96, v92
    v_max_f32 v92, 0, v92
    v_add_f32 v92, 0x3727c5ac, v92
    v_rcp_f32 v57, v92
    ds_write_b32 v7, v57 offset:12
    v_mov_b32 v1, 3
    ds_write_b32 v7, v1 offset:8
    s_branch L_exit
L_fin2:
    s_mov_b32 s14, 0
L_poll43:
    buffer_load_dwordx2 v[24:25], v11, s[48:51], s24 offen sc1
    s_add_u32 s14, s14, 1
    s_cmp_gt_u32 s14, 262144
    s_cbranch_scc1 L_exit
    s_waitcnt vmcnt(0)
    v_max_u32 v1, v24, v25
    v_cmp_eq_u32 vcc, -1, v1
    s_and_b64 exec, exec, vcc
    s_cbranch_scc1 L_poll43
    s_mov_b64 exec, -1
    v_mov_b32 v1, 2
    ds_write_b32 v7, v1 offset:8
    s_cmp_eq_u32 s80, 0
    s_cbranch_scc0 L_noep
    s_mov_b64 exec, 1
    buffer_store_dwordx2 v[2:3], v14, s[48:51], 0 offen sc1
    s_mov_b64 exec, -1
L_noep:
    v_lshlrev_b32 v56, 16, v24
    v_and_b32 v57, 0xffff0000, v24
    v_lshlrev_b32 v58, 16, v25
    v_and_b32 v59, 0xffff0000, v25
    s_nop 0
    v_permlane32_swap_b32 v56, v58
    v_permlane32_swap_b32 v57, v59
    v_add_f32 v56, v56, v58
    v_add_f32 v57, v57, v59
    s_nop 1
    v_permlane16_swap_b32 v56, v57
    v_add_f32 v56, v56, v57
    s_nop 1
    v_add_f32_dpp v56, v56, v56 row_ror:8 row_mask:0xf bank_mask:0xf
    s_lshl_b32 s10, s4, 7
    s_add_u32 s10, s10, 0x6000
    v_lshlrev_b32 v4, 2, v0
    s_mov_b64 exec, 0xfffffff
    s_mov_b32 s14, 0
L_hpoll:
    buffer_load_dword v1, v4, s[48:51], s10 offen sc1
    s_add_u32 s14, s14, 1
    s_cmp_gt_u32 s14, 262144
    s_cbranch_scc1 L_exit
    s_waitcnt vmcnt(0)
    v_cmp_eq_u32 vcc, v1, v2
    s_bcnt1_i32_b32 s11, vcc_lo
    s_cmp_lt_u32 s11, 24
    s_cbranch_scc1 L_hpoll
    s_mov_b64 exec, -1
    buffer_load_dwordx4 v[24:27], v9, s[48:51], s16 offen sc1
    buffer_load_dwordx4 v[28:31], v9, s[48:51], s17 offen sc1
    buffer_load_dwordx4 v[32:35], v9, s[48:51], s18 offen sc1
    buffer_load_dwordx4 v[36:39], v9, s[48:51], s19 offen sc1
    buffer_load_dwordx4 v[40:43], v9, s[48:51], s20 offen sc1
    buffer_load_dwordx4 v[44:47], v9, s[48:51], s21 offen sc1
    buffer_load_dwordx4 v[48:51], v9, s[48:51], s22 offen sc1
    s_mov_b32 s14, 0
L_spin44:
    ds_read_b32 v1, v7 offset:8
    s_add_u32 s14, s14, 1
    s_waitcnt lgkmcnt(0)
    v_readfirstlane_b32 s10, v1
    s_cmp_ge_u32 s10, 3
    s_cbranch_scc1 L_got45
    s_cmp_gt_u32 s14, 2097152
    s_cbranch_scc1 L_exit
    s_sleep 1
    s_branch L_spin44
L_got45:
    ds_read_b32 v57, v7 offset:12
    s_mov_b32 s14, 0
    s_waitcnt lgkmcnt(0)
    s_branch L_fmid
L_fpoll:
    buffer_load_dwordx4 v[24:27], v9, s[48:51], s16 offen sc1
    buffer_load_dwordx4 v[28:31], v9, s[48:51], s17 offen sc1
    buffer_load_dwordx4 v[32:35], v9, s[48:51], s18 offen sc1
    buffer_load_dwordx4 v[36:39], v9, s[48:51], s19 offen sc1
    buffer_load_dwordx4 v[40:43], v9, s[48:51], s20 offen sc1
    buffer_load_dwordx4 v[44:47], v9, s[48:51], s21 offen sc1
    buffer_load_dwordx4 v[48:51], v9, s[48:51], s22 offen sc1
    s_add_u32 s14, s14, 1
    s_cmp_gt_u32 s14, 262144
    s_cbranch_scc1 L_exit
L_fmid:
    s_waitcnt vmcnt(5)
    v_pk_add_f32 v[20:21], v[24:25], v[28:29]
    v_pk_add_f32 v[22:23], v[26:27], v[30:31]
    s_waitcnt vmcnt(4)
    v_pk_add_f32 v[20:21], v[20:21], v[32:33]
    v_pk_add_f32 v[22:23], v[22:23], v[34:35]
    s_waitcnt vmcnt(3)
    v_pk_add_f32 v[20:21], v[20:21], v[36:37]
    v_pk_add_f32 v[22:23], v[22:23], v[38:39]
    s_waitcnt vmcnt(2)
    v_pk_add_f32 v[20:21], v[20:21], v[40:41]
    v_pk_add_f32 v[22:23], v[22:23], v[42:43]
    s_waitcnt vmcnt(1)
    v_pk_add_f32 v[20:21], v[20:21], v[44:45]
    v_pk_add_f32 v[22:23], v[22:23], v[46:47]
    s_waitcnt vmcnt(0)
    v_pk_add_f32 v[20:21], v[20:21], v[48:49]
    v_pk_add_f32 v[22:23], v[22:23], v[50:51]
    v_pk_add_f32 v[52:53], v[20:21], v[22:23]
    v_cmp_u_f32 vcc, v52, v53
    s_cbranch_vccnz L_fslow
L_fok:
    s_mov_b64 exec, -1
    v_permlane32_swap_b32 v20, v22
    v_permlane32_swap_b32 v21, v23
    v_add_f32 v20, v20, v22
    v_add_f32 v21, v21, v23
    s_nop 1
    v_permlane16_swap_b32 v20, v21
    v_add_f32 v20, v20, v21
    s_nop 1
    v_add_f32_dpp v20, v20, v20 row_ror:8 row_mask:0xf bank_mask:0xf
    v_fma_f32 v20, v20, v57, v56
    s_mov_b32 exec_lo, 0x00ff00ff
    s_mov_b32 exec_hi, 0x00ff00ff
    v_cvt_pk_bf16_f32 v20, v20, v20
    buffer_store_short v20, v10, s[76:79], s23 offen
    s_endpgm
L_fslow:
    v_max3_u32 v1, v24, v25, v26
    v_max3_u32 v1, v1, v27, v28
    v_max3_u32 v1, v1, v29, v30
    v_max3_u32 v1, v1, v31, v32
    v_max3_u32 v1, v1, v33, v34
    v_max3_u32 v1, v1, v35, v36
    v_max3_u32 v1, v1, v37, v38
    v_max3_u32 v1, v1, v39, v40
    v_max3_u32 v1, v1, v41, v42
    v_max3_u32 v1, v1, v43, v44
    v_max3_u32 v1, v1, v45, v46
    v_max3_u32 v1, v1, v47, v48
    v_max3_u32 v1, v1, v49, v50
    v_max_u32 v1, v1, v51
    v_cmp_eq_u32 vcc, -1, v1
    s_and_b64 exec, exec, vcc
    s_cbranch_scc1 L_fpoll
    s_branch L_fok
L_exit:
L_end:
    s_endpgm
.section .rodata,"a"
.p2align 6
.amdhsa_kernel sequential_preLN__sliding_block_cached__glu_gated_bilinear__decode_kernel
  .amdhsa_next_free_vgpr 224
  .amdhsa_next_free_sgpr 102
  .amdhsa_accum_offset 224
  .amdhsa_group_segment_fixed_size 0
  .amdhsa_kernarg_size 96
  .amdhsa_user_sgpr_count 2
  .amdhsa_user_sgpr_kernarg_segment_ptr 1
  .amdhsa_system_sgpr_workgroup_id_x 1
  .amdhsa_float_denorm_mode_32 3
.end_amdhsa_kernel
```
